```python
import torch

def _softmax(x, axis=-1):
    return torch.softmax(x, dim=axis)

def _gelu(x):
    return torch.nn.functional.gelu(x, approximate='tanh')

def _silu(x):
    return torch.nn.functional.silu(x)

def _sigmoid(x):
    return torch.sigmoid(x)

def _layernorm(x, axis=-1, eps=1e-05):
    m = x.mean(dim=axis, keepdim=True)
    v = x.var(dim=axis, keepdim=True, unbiased=False)
    return (x - m) / torch.sqrt(v + eps)

def _scatter_add(tgt, idx, src, axis=0):
    return tgt.clone().index_add_(axis, idx, src)

def _segment_sum(src, seg, n):
    out = torch.zeros((n,) + src.shape[1:], dtype=src.dtype)
    return out.index_add_(0, seg, src)

def _pad(x, pw):
    flat = tuple((v for pair in reversed(pw) for v in pair))
    return torch.nn.functional.pad(x, flat)
kernel_name = 'adaLN_cond__spectral_fnet__dense_activation_relu__prompt'

def setup_inputs():

    _w = lambda a: (lambda t: t.to(torch.bfloat16) if t.is_floating_point() else t)(torch.as_tensor(a))

    def _A_setup():
        B, S, D = (1, 2048, 576)
        ns = torch.arange(S)[:, None] * torch.arange(S)[None, :]
        nd = torch.arange(D)[:, None] * torch.arange(D)[None, :]
        Ws_re = torch.cos(-2.0 * torch.pi * ns / S).to(float)
        Ws_im = torch.sin(-2.0 * torch.pi * ns / S).to(float)
        Wd_re = torch.cos(-2.0 * torch.pi * nd / D).to(float)
        Wd_im = torch.sin(-2.0 * torch.pi * nd / D).to(float)
        return {'x': _w((lambda *s: torch.randn(*s, dtype=torch.bfloat16) * 0.05)(B, S, D)), 'dft_seq_re': _w(Ws_re), 'dft_seq_im': _w(Ws_im), 'dft_hid_re': _w(Wd_re), 'dft_hid_im': _w(Wd_im)}
    _A_in = _A_setup()

    def _B_setup():
        B, S, D, Dff = (1, 2048, 576, 4608)
        return {'x': _w((lambda *s: torch.randn(*s, dtype=torch.bfloat16) * 0.05)(B, S, D)), 'w1': _w((lambda *s: torch.randn(*s, dtype=torch.bfloat16) * 1.6)(D, Dff)), 'w2': _w((lambda *s: torch.randn(*s, dtype=torch.bfloat16) * 1.6)(Dff, D))}
    _B_in = _B_setup()
    return {'A_x': _A_in['x'], 'A_dft_seq_re': _A_in['dft_seq_re'], 'A_dft_seq_im': _A_in['dft_seq_im'], 'A_dft_hid_re': _A_in['dft_hid_re'], 'A_dft_hid_im': _A_in['dft_hid_im'], 'B_x': _B_in['x'], 'B_w1': _B_in['w1'], 'B_w2': _B_in['w2'], 'c': _w((lambda *s: torch.randn(*s, dtype=torch.bfloat16) * 0.1)(1, 576) * 8.0), 'w_mod': _w((lambda *s: torch.randn(*s, dtype=torch.bfloat16) * 0.1)(576, 6 * 576) * 576 ** (-0.5) * 8.0)}

def reference(A_x, A_dft_seq_re, A_dft_seq_im, A_dft_hid_re, A_dft_hid_im, B_x, B_w1, B_w2, c, w_mod):

    def _A_ref(x, dft_seq_re, dft_seq_im, dft_hid_re, dft_hid_im):
        a = torch.einsum('bsd,ed->bse', x, dft_hid_re)
        b = torch.einsum('bsd,ed->bse', x, dft_hid_im)
        y = torch.einsum('ts,bse->bte', dft_seq_re, a) - torch.einsum('ts,bse->bte', dft_seq_im, b)
        return y

    def _B_ref(x, w1, w2):
        h = torch.einsum('bsd,df->bsf', x, w1)
        zero = torch.zeros_like(h)
        h = torch.maximum(h, zero)
        return torch.einsum('bsf,fd->bsd', h, w2)
    x = A_x
    mod = (_silu(c) @ w_mod).reshape(c.shape[0], 6, 1, -1)
    sa, ca, ga, sb, cb, gb = (mod[:, 0].clone(), mod[:, 1].clone(), mod[:, 2].clone(), mod[:, 3].clone(), mod[:, 4].clone(), mod[:, 5].clone())
    h = _layernorm(x, axis=-1) * (1 + ca) + sa
    x = x + ga * _A_ref(h, A_dft_seq_re, A_dft_seq_im, A_dft_hid_re, A_dft_hid_im)
    h = _layernorm(x, axis=-1) * (1 + cb) + sb
    x = x + gb * _B_ref(h, B_w1, B_w2)
    return x
```

```asm
; @launch kernel=k1_mod_kernel grid=(256,1,1) block=(256,1,1) lds=2048
; @launch kernel=k2_hid_kernel grid=(256,1,1) block=(512,1,1) lds=135168
; @launch kernel=k3_seq_kernel grid=(256,1,1) block=(512,1,1) lds=111616
; @launch kernel=k4_mlp_kernel grid=(256,1,1) block=(512,1,1) lds=160768
.amdgcn_target "amdgcn-amd-amdhsa--gfx950"
.text
.globl k1_mod_kernel
.p2align 8
.type k1_mod_kernel,@function
k1_mod_kernel:
    s_load_dwordx2 s[8:9], s[0:1], 72
    s_load_dwordx2 s[12:13], s[0:1], 64
    s_load_dwordx2 s[16:17], s[0:1], 96
    s_load_dwordx2 s[20:21], s[0:1], 0
    s_load_dwordx2 s[40:41], s[0:1], 24
    s_load_dwordx2 s[44:45], s[0:1], 32
    s_load_dwordx2 s[64:65], s[0:1], 48
    s_mov_b32 s10, 3981312
    s_mov_b32 s11, 0x00020000
    s_mov_b32 s14, 1152
    s_mov_b32 s15, 0x00020000
    s_mov_b32 s18, 268435456
    s_mov_b32 s19, 0x00020000
    s_mov_b32 s22, 2359296
    s_mov_b32 s23, 0x00020000
    s_mov_b32 s42, 663552
    s_mov_b32 s43, 0x00020000
    s_mov_b32 s46, 663552
    s_mov_b32 s47, 0x00020000
    s_mov_b32 s66, 5308416
    s_mov_b32 s67, 0x00020000
    s_cmp_ge_u32 s2, 256
    s_cbranch_scc1 k1_end_2
    s_cmp_ge_u32 s2, 144
    s_cbranch_scc1 k1_pf_1
    s_and_b32 s28, s2, 7
    s_lshr_b32 s29, s2, 3
    s_lshl_b32 s24, s29, 7
    s_mul_i32 s30, s28, 72
    v_and_b32 v1, 7, v0
    v_lshrrev_b32 v2, 3, v0
    v_add_u32 v4, s30, v2
    v_mul_u32_u24 v3, 6912, v4
    v_lshl_add_u32 v3, v1, 4, v3
    v_lshlrev_b32 v4, 1, v4
    v_cmp_gt_u32 vcc, 8, v2
    v_mov_b32 v120, 0x40000000
    s_nop 0
    v_cndmask_b32 v5, v120, v3, vcc
    s_waitcnt lgkmcnt(0)
    buffer_load_dwordx4 v[32:35], v3, s[8:11], s24 offen
    s_add_u32 s24, s24, 221184
    buffer_load_dwordx4 v[36:39], v3, s[8:11], s24 offen
    s_add_u32 s24, s24, 221184
    buffer_load_dwordx4 v[40:43], v5, s[8:11], s24 offen
    buffer_load_ushort v8, v4, s[12:15], 0 offen offset:0
    buffer_load_ushort v9, v4, s[12:15], 0 offen offset:64
    buffer_load_ushort v10, v4, s[12:15], 0 offen offset:128
    s_and_b32 s56, s2, 7
    s_lshr_b32 s57, s2, 3
    v_mov_b32 v69, 0x40000000
    s_cmp_lt_u32 s57, 9
    s_cbranch_scc1 pfx_4
    s_cmp_lt_u32 s57, 21
    s_cbranch_scc1 pfh_5
    s_cmp_lt_u32 s57, 30
    s_cbranch_scc1 pfs_6
    s_getpc_b64 s[58:59]
k1_pc_3:
    s_sub_u32 s57, s57, 30
    s_lshl_b32 s57, s57, 15
    v_lshlrev_b32 v64, 7, v0
    v_add_u32 v64, s57, v64
    v_min_u32 v65, code_end-k1_pc_3, v64
    global_load_dword v72, v65, s[58:59]
    s_branch pfd_8
pfx_4:
    s_lshl_b32 s58, s57, 8
    v_add_u32 v64, s58, v0
    s_mov_b32 s59, 477218589
    v_mul_hi_u32 v65, v64, s59
    v_mul_u32_u24 v66, 9, v65
    v_sub_u32 v66, v64, v66
    v_lshrrev_b32 v67, 5, v65
    v_lshlrev_b32 v67, 3, v67
    v_add_u32 v67, s56, v67
    v_lshlrev_b32 v67, 4, v67
    v_and_b32 v68, 15, v65
    v_add_u32 v67, v67, v68
    v_sub_u32 v68, 2048, v67
    v_and_b32 v70, 16, v65
    v_cmp_eq_u32 vcc, 0, v70
    s_nop 1
    v_cndmask_b32 v67, v68, v67, vcc
    v_mul_u32_u24 v67, 1152, v67
    v_lshl_add_u32 v67, v66, 7, v67
    buffer_load_dword v72, v67, s[20:23], 0 offen
    s_branch pfd_8
pfh_5:
    s_sub_u32 s57, s57, 9
    s_cmp_ge_u32 s57, 6
    s_cselect_b32 s60, s44, s40
    s_cselect_b32 s61, s45, s41
    s_cselect_b32 s58, 6, 0
    s_mov_b32 s62, 663552
    s_mov_b32 s63, 0x00020000
    s_sub_u32 s57, s57, s58
    s_lshl_b32 s58, s57, 8
    v_add_u32 v71, s58, v0
    s_mov_b32 s59, 858993460
    v_mul_hi_u32 v65, v71, s59
    v_mul_u32_u24 v66, 5, v65
    v_sub_u32 v66, v71, v66
    v_mul_u32_u24 v68, 1152, v65
    v_lshl_add_u32 v68, v66, 7, v68
    buffer_load_dword v72, v68, s[60:63], 0 offen
    s_branch pfd_8
pfs_6:
    s_sub_u32 s57, s57, 21
    s_lshl_b32 s58, s57, 8
    v_add_u32 v64, s58, v0
    s_mov_b32 s59, 477218589
    v_mul_hi_u32 v65, v64, s59
    v_mul_u32_u24 v66, 9, v65
    v_sub_u32 v66, v64, v66
    v_mul_u32_u24 v65, 9216, v65
    v_lshl_add_u32 v65, v66, 7, v65
    v_cmp_gt_u32 vcc, 1152, v64
    s_nop 1
    v_cndmask_b32 v65, v69, v65, vcc
    s_mul_i32 s58, s56, 1152
    buffer_load_dword v74, v65, s[64:67], s58 offen
pfd_8:
    v_mov_b32 v112, 0
    v_mov_b32 v113, 0
    v_mov_b32 v114, 0
    v_mov_b32 v115, 0
    v_mov_b32 v116, 0
    v_mov_b32 v117, 0
    v_mov_b32 v118, 0
    v_mov_b32 v119, 0
    s_mov_b32 s25, 0x3fb8aa3b
    s_waitcnt vmcnt(1)
    v_lshlrev_b32 v8, 16, v8
    v_mul_f32 v120, s25, v8
    v_exp_f32 v120, -v120
    s_nop 0
    v_add_f32 v120, 1.0, v120
    v_rcp_f32 v120, v120
    s_nop 0
    v_mul_f32 v8, v8, v120
    v_cvt_pk_bf16_f32 v8, v8, v8
    v_and_b32 v8, 0xffff0000, v8
    v_lshlrev_b32 v9, 16, v9
    v_mul_f32 v120, s25, v9
    v_exp_f32 v120, -v120
    s_nop 0
    v_add_f32 v120, 1.0, v120
    v_rcp_f32 v120, v120
    s_nop 0
    v_mul_f32 v9, v9, v120
    v_cvt_pk_bf16_f32 v9, v9, v9
    v_and_b32 v9, 0xffff0000, v9
    v_lshlrev_b32 v10, 16, v10
    v_mul_f32 v120, s25, v10
    v_exp_f32 v120, -v120
    s_nop 0
    v_add_f32 v120, 1.0, v120
    v_rcp_f32 v120, v120
    s_nop 0
    v_mul_f32 v10, v10, v120
    v_cvt_pk_bf16_f32 v10, v10, v10
    v_and_b32 v10, 0xffff0000, v10
    v_lshlrev_b32 v120, 16, v32
    v_and_b32 v121, 0xffff0000, v32
    v_fmac_f32 v112, v120, v8
    v_fmac_f32 v113, v121, v8
    v_lshlrev_b32 v120, 16, v33
    v_and_b32 v121, 0xffff0000, v33
    v_fmac_f32 v114, v120, v8
    v_fmac_f32 v115, v121, v8
    v_lshlrev_b32 v120, 16, v34
    v_and_b32 v121, 0xffff0000, v34
    v_fmac_f32 v116, v120, v8
    v_fmac_f32 v117, v121, v8
    v_lshlrev_b32 v120, 16, v35
    v_and_b32 v121, 0xffff0000, v35
    v_fmac_f32 v118, v120, v8
    v_fmac_f32 v119, v121, v8
    v_lshlrev_b32 v120, 16, v36
    v_and_b32 v121, 0xffff0000, v36
    v_fmac_f32 v112, v120, v9
    v_fmac_f32 v113, v121, v9
    v_lshlrev_b32 v120, 16, v37
    v_and_b32 v121, 0xffff0000, v37
    v_fmac_f32 v114, v120, v9
    v_fmac_f32 v115, v121, v9
    v_lshlrev_b32 v120, 16, v38
    v_and_b32 v121, 0xffff0000, v38
    v_fmac_f32 v116, v120, v9
    v_fmac_f32 v117, v121, v9
    v_lshlrev_b32 v120, 16, v39
    v_and_b32 v121, 0xffff0000, v39
    v_fmac_f32 v118, v120, v9
    v_fmac_f32 v119, v121, v9
    v_lshlrev_b32 v120, 16, v40
    v_and_b32 v121, 0xffff0000, v40
    v_fmac_f32 v112, v120, v10
    v_fmac_f32 v113, v121, v10
    v_lshlrev_b32 v120, 16, v41
    v_and_b32 v121, 0xffff0000, v41
    v_fmac_f32 v114, v120, v10
    v_fmac_f32 v115, v121, v10
    v_lshlrev_b32 v120, 16, v42
    v_and_b32 v121, 0xffff0000, v42
    v_fmac_f32 v116, v120, v10
    v_fmac_f32 v117, v121, v10
    v_lshlrev_b32 v120, 16, v43
    v_and_b32 v121, 0xffff0000, v43
    v_fmac_f32 v118, v120, v10
    v_fmac_f32 v119, v121, v10
    s_nop 1
    v_add_f32_dpp v112, v112, v112 row_ror:8 row_mask:0xf bank_mask:0xf
    v_add_f32_dpp v113, v113, v113 row_ror:8 row_mask:0xf bank_mask:0xf
    v_add_f32_dpp v114, v114, v114 row_ror:8 row_mask:0xf bank_mask:0xf
    v_add_f32_dpp v115, v115, v115 row_ror:8 row_mask:0xf bank_mask:0xf
    v_add_f32_dpp v116, v116, v116 row_ror:8 row_mask:0xf bank_mask:0xf
    v_add_f32_dpp v117, v117, v117 row_ror:8 row_mask:0xf bank_mask:0xf
    v_add_f32_dpp v118, v118, v118 row_ror:8 row_mask:0xf bank_mask:0xf
    v_add_f32_dpp v119, v119, v119 row_ror:8 row_mask:0xf bank_mask:0xf
    v_mov_b32 v96, v112
    v_mov_b32 v97, v113
    v_mov_b32 v98, v114
    v_mov_b32 v99, v115
    v_mov_b32 v100, v116
    v_mov_b32 v101, v117
    v_mov_b32 v102, v118
    v_mov_b32 v103, v119
    s_nop 1
    v_permlane16_swap_b32 v96, v112
    v_permlane16_swap_b32 v97, v113
    v_permlane16_swap_b32 v98, v114
    v_permlane16_swap_b32 v99, v115
    v_permlane16_swap_b32 v100, v116
    v_permlane16_swap_b32 v101, v117
    v_permlane16_swap_b32 v102, v118
    v_permlane16_swap_b32 v103, v119
    s_nop 1
    v_add_f32 v112, v112, v96
    v_add_f32 v113, v113, v97
    v_add_f32 v114, v114, v98
    v_add_f32 v115, v115, v99
    v_add_f32 v116, v116, v100
    v_add_f32 v117, v117, v101
    v_add_f32 v118, v118, v102
    v_add_f32 v119, v119, v103
    v_mov_b32 v96, v112
    v_mov_b32 v97, v113
    v_mov_b32 v98, v114
    v_mov_b32 v99, v115
    v_mov_b32 v100, v116
    v_mov_b32 v101, v117
    v_mov_b32 v102, v118
    v_mov_b32 v103, v119
    s_nop 1
    v_permlane32_swap_b32 v96, v112
    v_permlane32_swap_b32 v97, v113
    v_permlane32_swap_b32 v98, v114
    v_permlane32_swap_b32 v99, v115
    v_permlane32_swap_b32 v100, v116
    v_permlane32_swap_b32 v101, v117
    v_permlane32_swap_b32 v102, v118
    v_permlane32_swap_b32 v103, v119
    s_nop 1
    v_add_f32 v112, v112, v96
    v_add_f32 v113, v113, v97
    v_add_f32 v114, v114, v98
    v_add_f32 v115, v115, v99
    v_add_f32 v116, v116, v100
    v_add_f32 v117, v117, v101
    v_add_f32 v118, v118, v102
    v_add_f32 v119, v119, v103
    v_lshrrev_b32 v120, 6, v0
    v_lshlrev_b32 v120, 8, v120
    v_lshl_add_u32 v120, v1, 5, v120
    s_mov_b64 exec, 0xff
    ds_write_b128 v120, v[112:115]
    ds_write_b128 v120, v[116:119] offset:16
    s_mov_b64 exec, -1
    s_waitcnt lgkmcnt(0)
    s_barrier
    v_cmp_gt_u32 vcc, 64, v0
    s_and_saveexec_b64 s[26:27], vcc
    s_cbranch_execz k1_end_2
    v_lshlrev_b32 v120, 2, v0
    ds_read_b32 v32, v120 offset:0
    ds_read_b32 v33, v120 offset:256
    ds_read_b32 v34, v120 offset:512
    ds_read_b32 v35, v120 offset:768
    s_cmp_ge_u32 s29, 9
    s_cselect_b32 s31, 9, 0
    s_cselect_b32 s32, 576, 0
    s_sub_u32 s31, s29, s31
    s_lshl_b32 s31, s31, 6
    v_add_u32 v3, s31, v0
    v_sub_u32 v4, 864, v3
    v_cmp_lt_u32 vcc, 288, v3
    s_nop 1
    v_cndmask_b32 v3, v3, v4, vcc
    s_mul_i32 s33, s28, 1152
    s_add_u32 s33, s33, s32
    v_add_u32 v3, s33, v3
    v_lshlrev_b32 v3, 2, v3
    s_mov_b32 s33, 32768
    s_waitcnt lgkmcnt(0)
    v_add_f32 v32, v32, v34
    v_add_f32 v33, v33, v35
    v_add_f32 v32, v32, v33
    buffer_store_dword v32, v3, s[16:19], s33 offen
    s_endpgm
k1_pf_1:
    s_waitcnt lgkmcnt(0)
    s_and_b32 s56, s2, 7
    s_lshr_b32 s57, s2, 3
    v_mov_b32 v69, 0x40000000
    s_cmp_lt_u32 s57, 9
    s_cbranch_scc1 pfx_10
    s_cmp_lt_u32 s57, 21
    s_cbranch_scc1 pfh_11
    s_cmp_lt_u32 s57, 30
    s_cbranch_scc1 pfs_12
    s_getpc_b64 s[58:59]
k1_pc_9:
    s_sub_u32 s57, s57, 30
    s_lshl_b32 s57, s57, 15
    v_lshlrev_b32 v64, 7, v0
    v_add_u32 v64, s57, v64
    v_min_u32 v65, code_end-k1_pc_9, v64
    global_load_dword v72, v65, s[58:59]
    s_branch pfd_14
pfx_10:
    s_lshl_b32 s58, s57, 8
    v_add_u32 v64, s58, v0
    s_mov_b32 s59, 477218589
    v_mul_hi_u32 v65, v64, s59
    v_mul_u32_u24 v66, 9, v65
    v_sub_u32 v66, v64, v66
    v_lshrrev_b32 v67, 5, v65
    v_lshlrev_b32 v67, 3, v67
    v_add_u32 v67, s56, v67
    v_lshlrev_b32 v67, 4, v67
    v_and_b32 v68, 15, v65
    v_add_u32 v67, v67, v68
    v_sub_u32 v68, 2048, v67
    v_and_b32 v70, 16, v65
    v_cmp_eq_u32 vcc, 0, v70
    s_nop 1
    v_cndmask_b32 v67, v68, v67, vcc
    v_mul_u32_u24 v67, 1152, v67
    v_lshl_add_u32 v67, v66, 7, v67
    buffer_load_dword v72, v67, s[20:23], 0 offen
    s_branch pfd_14
pfh_11:
    s_sub_u32 s57, s57, 9
    s_cmp_ge_u32 s57, 6
    s_cselect_b32 s60, s44, s40
    s_cselect_b32 s61, s45, s41
    s_cselect_b32 s58, 6, 0
    s_mov_b32 s62, 663552
    s_mov_b32 s63, 0x00020000
    s_sub_u32 s57, s57, s58
    s_lshl_b32 s58, s57, 8
    v_add_u32 v71, s58, v0
    s_mov_b32 s59, 858993460
    v_mul_hi_u32 v65, v71, s59
    v_mul_u32_u24 v66, 5, v65
    v_sub_u32 v66, v71, v66
    v_mul_u32_u24 v68, 1152, v65
    v_lshl_add_u32 v68, v66, 7, v68
    buffer_load_dword v72, v68, s[60:63], 0 offen
    s_branch pfd_14
pfs_12:
    s_sub_u32 s57, s57, 21
    s_lshl_b32 s58, s57, 8
    v_add_u32 v64, s58, v0
    s_mov_b32 s59, 477218589
    v_mul_hi_u32 v65, v64, s59
    v_mul_u32_u24 v66, 9, v65
    v_sub_u32 v66, v64, v66
    v_mul_u32_u24 v65, 9216, v65
    v_lshl_add_u32 v65, v66, 7, v65
    v_cmp_gt_u32 vcc, 1152, v64
    s_nop 1
    v_cndmask_b32 v65, v69, v65, vcc
    s_mul_i32 s58, s56, 1152
    buffer_load_dword v74, v65, s[64:67], s58 offen
pfd_14:
    s_waitcnt vmcnt(0)
k1_end_2:
    s_endpgm
.globl k2_hid_kernel
.p2align 8
.type k2_hid_kernel,@function
k2_hid_kernel:
    s_load_dwordx2 s[8:9], s[0:1], 0
    s_load_dwordx2 s[12:13], s[0:1], 24
    s_load_dwordx2 s[16:17], s[0:1], 96
    s_load_dwordx2 s[20:21], s[0:1], 32
    s_load_dwordx2 s[24:25], s[0:1], 48
    s_load_dwordx2 s[56:57], s[0:1], 72
    s_load_dwordx2 s[60:61], s[0:1], 64
    s_load_dwordx2 s[68:69], s[0:1], 8
    s_load_dwordx2 s[72:73], s[0:1], 16
    s_mov_b32 s10, 2359296
    s_mov_b32 s11, 0x00020000
    s_mov_b32 s14, 663552
    s_mov_b32 s15, 0x00020000
    s_mov_b32 s18, 268435456
    s_mov_b32 s19, 0x00020000
    s_mov_b32 s22, 663552
    s_mov_b32 s23, 0x00020000
    s_mov_b32 s26, 5308416
    s_mov_b32 s27, 0x00020000
    s_mov_b32 s58, 3981312
    s_mov_b32 s59, 0x00020000
    s_mov_b32 s62, 1152
    s_mov_b32 s63, 0x00020000
    s_mov_b32 s70, 8388608
    s_mov_b32 s71, 0x00020000
    s_mov_b32 s74, 8388608
    s_mov_b32 s75, 0x00020000
    s_cmp_ge_u32 s2, 256
    s_cbranch_scc1 k2_end_16
    s_cmp_ge_u32 s2, 130
    s_cbranch_scc1 k2_pf_15
    s_bfe_u32 s29, s2, 0x10003
    s_lshr_b32 s32, s2, 4
    s_lshl_b32 s32, s32, 3
    s_and_b32 s33, s2, 7
    s_add_u32 s28, s32, s33
    s_cmp_ge_u32 s2, 128
    s_cselect_b32 s28, 64, s28
    s_cselect_b32 s29, s33, s29
    v_lshrrev_b32 v10, 6, v0
    v_and_b32 v12, 63, v0
    v_readfirstlane_b32 s30, v10
    s_nop 3
    s_cmp_ge_u32 s30, 4
    s_cbranch_scc1 k2_mf_17
    v_lshrrev_b32 v1, 4, v0
    v_and_b32 v2, 15, v0
    s_lshl_b32 s31, s28, 4
    v_add_u32 v3, s31, v1
    v_cmp_gt_u32 s[32:33], 12, v2
    v_cmp_eq_u32 s[34:35], 12, v2
    v_cmp_ge_u32 vcc, 1024, v3
    s_and_b64 s[36:37], vcc, s[32:33]
    v_add_u32 v10, -1, v3
    v_cmp_gt_u32 vcc, 1023, v10
    s_mov_b64 s[38:39], vcc
    s_and_b64 s[40:41], s[38:39], s[32:33]
    v_lshlrev_b32 v10, 4, v2
    v_mul_u32_u24 v4, 1152, v3
    v_sub_u32 v11, 2048, v3
    v_mul_u32_u24 v6, 1152, v11
    v_sub_u32 v5, v4, v10
    v_add_u32 v5, 752, v5
    v_sub_u32 v7, v6, v10
    v_add_u32 v7, 752, v7
    v_add_u32 v4, v4, v10
    v_add_u32 v6, v6, v10
    v_mov_b32 v11, 0x40000000
    v_cndmask_b32 v4, v11, v4, s[36:37]
    v_cndmask_b32 v5, v11, v5, s[36:37]
    v_cndmask_b32 v6, v11, v6, s[40:41]
    v_cndmask_b32 v7, v11, v7, s[40:41]
    s_waitcnt lgkmcnt(0)
    buffer_load_dwordx4 v[36:39], v4, s[8:11], 0 offen offset:0
    buffer_load_dwordx4 v[44:47], v4, s[8:11], 0 offen offset:192
    buffer_load_dwordx4 v[52:55], v4, s[8:11], 0 offen offset:384
    buffer_load_dwordx4 v[60:63], v5, s[8:11], 0 offen offset:384
    buffer_load_dwordx4 v[68:71], v5, s[8:11], 0 offen offset:192
    buffer_load_dwordx4 v[76:79], v5, s[8:11], 0 offen offset:0
    buffer_load_dwordx4 v[84:87], v6, s[8:11], 0 offen offset:0
    buffer_load_dwordx4 v[92:95], v6, s[8:11], 0 offen offset:192
    buffer_load_dwordx4 v[100:103], v6, s[8:11], 0 offen offset:384
    buffer_load_dwordx4 v[108:111], v7, s[8:11], 0 offen offset:384
    buffer_load_dwordx4 v[116:119], v7, s[8:11], 0 offen offset:192
    buffer_load_dwordx4 v[124:127], v7, s[8:11], 0 offen offset:0
    s_barrier
    v_min_u32 v8, 11, v2
    v_lshlrev_b32 v8, 5, v8
    v_add_u32 v8, 19456, v8
    v_add_u32 v9, 1152, v8
    v_mov_b32 v11, 19840
    v_cndmask_b32 v9, v9, v11, s[34:35]
    s_waitcnt vmcnt(6)
    v_lshlrev_b32 v32, 16, v36
    v_and_b32 v33, 0xffff0000, v36
    v_lshlrev_b32 v34, 16, v37
    v_and_b32 v35, 0xffff0000, v37
    v_lshlrev_b32 v36, 16, v38
    v_and_b32 v37, 0xffff0000, v38
    v_lshlrev_b32 v38, 16, v39
    v_and_b32 v39, 0xffff0000, v39
    v_lshlrev_b32 v56, 16, v61
    v_and_b32 v59, 0xffff0000, v61
    v_lshlrev_b32 v58, 16, v62
    v_and_b32 v61, 0xffff0000, v62
    v_and_b32 v57, 0xffff0000, v60
    v_lshlrev_b32 v62, 16, v60
    v_lshlrev_b32 v60, 16, v63
    v_and_b32 v63, 0xffff0000, v63
    v_lshlrev_b32 v40, 16, v44
    v_and_b32 v41, 0xffff0000, v44
    v_lshlrev_b32 v42, 16, v45
    v_and_b32 v43, 0xffff0000, v45
    v_lshlrev_b32 v44, 16, v46
    v_and_b32 v45, 0xffff0000, v46
    v_lshlrev_b32 v46, 16, v47
    v_and_b32 v47, 0xffff0000, v47
    v_lshlrev_b32 v64, 16, v69
    v_and_b32 v67, 0xffff0000, v69
    v_lshlrev_b32 v66, 16, v70
    v_and_b32 v69, 0xffff0000, v70
    v_and_b32 v65, 0xffff0000, v68
    v_lshlrev_b32 v70, 16, v68
    v_lshlrev_b32 v68, 16, v71
    v_and_b32 v71, 0xffff0000, v71
    v_lshlrev_b32 v48, 16, v52
    v_and_b32 v49, 0xffff0000, v52
    v_lshlrev_b32 v50, 16, v53
    v_and_b32 v51, 0xffff0000, v53
    v_lshlrev_b32 v52, 16, v54
    v_and_b32 v53, 0xffff0000, v54
    v_lshlrev_b32 v54, 16, v55
    v_and_b32 v55, 0xffff0000, v55
    v_lshlrev_b32 v72, 16, v77
    v_and_b32 v75, 0xffff0000, v77
    v_lshlrev_b32 v74, 16, v78
    v_and_b32 v77, 0xffff0000, v78
    v_and_b32 v73, 0xffff0000, v76
    v_lshlrev_b32 v78, 16, v76
    v_lshlrev_b32 v76, 16, v79
    v_and_b32 v79, 0xffff0000, v79
    s_waitcnt vmcnt(0)
    v_lshlrev_b32 v80, 16, v84
    v_and_b32 v81, 0xffff0000, v84
    v_lshlrev_b32 v82, 16, v85
    v_and_b32 v83, 0xffff0000, v85
    v_lshlrev_b32 v84, 16, v86
    v_and_b32 v85, 0xffff0000, v86
    v_lshlrev_b32 v86, 16, v87
    v_and_b32 v87, 0xffff0000, v87
    v_lshlrev_b32 v104, 16, v109
    v_and_b32 v107, 0xffff0000, v109
    v_lshlrev_b32 v106, 16, v110
    v_and_b32 v109, 0xffff0000, v110
    v_and_b32 v105, 0xffff0000, v108
    v_lshlrev_b32 v110, 16, v108
    v_lshlrev_b32 v108, 16, v111
    v_and_b32 v111, 0xffff0000, v111
    v_lshlrev_b32 v88, 16, v92
    v_and_b32 v89, 0xffff0000, v92
    v_lshlrev_b32 v90, 16, v93
    v_and_b32 v91, 0xffff0000, v93
    v_lshlrev_b32 v92, 16, v94
    v_and_b32 v93, 0xffff0000, v94
    v_lshlrev_b32 v94, 16, v95
    v_and_b32 v95, 0xffff0000, v95
    v_lshlrev_b32 v112, 16, v117
    v_and_b32 v115, 0xffff0000, v117
    v_lshlrev_b32 v114, 16, v118
    v_and_b32 v117, 0xffff0000, v118
    v_and_b32 v113, 0xffff0000, v116
    v_lshlrev_b32 v118, 16, v116
    v_lshlrev_b32 v116, 16, v119
    v_and_b32 v119, 0xffff0000, v119
    v_lshlrev_b32 v96, 16, v100
    v_and_b32 v97, 0xffff0000, v100
    v_lshlrev_b32 v98, 16, v101
    v_and_b32 v99, 0xffff0000, v101
    v_lshlrev_b32 v100, 16, v102
    v_and_b32 v101, 0xffff0000, v102
    v_lshlrev_b32 v102, 16, v103
    v_and_b32 v103, 0xffff0000, v103
    v_lshlrev_b32 v120, 16, v125
    v_and_b32 v123, 0xffff0000, v125
    v_lshlrev_b32 v122, 16, v126
    v_and_b32 v125, 0xffff0000, v126
    v_and_b32 v121, 0xffff0000, v124
    v_lshlrev_b32 v126, 16, v124
    v_lshlrev_b32 v124, 16, v127
    v_and_b32 v127, 0xffff0000, v127
    v_pk_add_f32 v[22:23], v[32:33], v[34:35]
    v_pk_add_f32 v[24:25], v[80:81], v[82:83]
    v_pk_add_f32 v[22:23], v[22:23], v[36:37]
    v_pk_add_f32 v[24:25], v[24:25], v[84:85]
    v_pk_add_f32 v[22:23], v[22:23], v[38:39]
    v_pk_add_f32 v[24:25], v[24:25], v[86:87]
    v_pk_add_f32 v[22:23], v[22:23], v[40:41]
    v_pk_add_f32 v[24:25], v[24:25], v[88:89]
    v_pk_add_f32 v[22:23], v[22:23], v[42:43]
    v_pk_add_f32 v[24:25], v[24:25], v[90:91]
    v_pk_add_f32 v[22:23], v[22:23], v[44:45]
    v_pk_add_f32 v[24:25], v[24:25], v[92:93]
    v_pk_add_f32 v[22:23], v[22:23], v[46:47]
    v_pk_add_f32 v[24:25], v[24:25], v[94:95]
    v_pk_add_f32 v[22:23], v[22:23], v[48:49]
    v_pk_add_f32 v[24:25], v[24:25], v[96:97]
    v_pk_add_f32 v[22:23], v[22:23], v[50:51]
    v_pk_add_f32 v[24:25], v[24:25], v[98:99]
    v_pk_add_f32 v[22:23], v[22:23], v[52:53]
    v_pk_add_f32 v[24:25], v[24:25], v[100:101]
    v_pk_add_f32 v[22:23], v[22:23], v[54:55]
    v_pk_add_f32 v[24:25], v[24:25], v[102:103]
    v_pk_add_f32 v[22:23], v[22:23], v[56:57]
    v_pk_add_f32 v[24:25], v[24:25], v[104:105]
    v_pk_add_f32 v[22:23], v[22:23], v[58:59]
    v_pk_add_f32 v[24:25], v[24:25], v[106:107]
    v_pk_add_f32 v[22:23], v[22:23], v[60:61]
    v_pk_add_f32 v[24:25], v[24:25], v[108:109]
    v_pk_add_f32 v[22:23], v[22:23], v[62:63]
    v_pk_add_f32 v[24:25], v[24:25], v[110:111]
    v_pk_add_f32 v[22:23], v[22:23], v[64:65]
    v_pk_add_f32 v[24:25], v[24:25], v[112:113]
    v_pk_add_f32 v[22:23], v[22:23], v[66:67]
    v_pk_add_f32 v[24:25], v[24:25], v[114:115]
    v_pk_add_f32 v[22:23], v[22:23], v[68:69]
    v_pk_add_f32 v[24:25], v[24:25], v[116:117]
    v_pk_add_f32 v[22:23], v[22:23], v[70:71]
    v_pk_add_f32 v[24:25], v[24:25], v[118:119]
    v_pk_add_f32 v[22:23], v[22:23], v[72:73]
    v_pk_add_f32 v[24:25], v[24:25], v[120:121]
    v_pk_add_f32 v[22:23], v[22:23], v[74:75]
    v_pk_add_f32 v[24:25], v[24:25], v[122:123]
    v_pk_add_f32 v[22:23], v[22:23], v[76:77]
    v_pk_add_f32 v[24:25], v[24:25], v[124:125]
    v_pk_add_f32 v[22:23], v[22:23], v[78:79]
    v_pk_add_f32 v[24:25], v[24:25], v[126:127]
    v_add_f32 v26, v22, v23
    v_add_f32 v27, v24, v25
    s_nop 1
    v_add_f32_dpp v26, v26, v26 row_ror:8 row_mask:0xf bank_mask:0xf
    v_add_f32_dpp v27, v27, v27 row_ror:8 row_mask:0xf bank_mask:0xf
    s_nop 1
    v_add_f32_dpp v26, v26, v26 row_ror:4 row_mask:0xf bank_mask:0xf
    v_add_f32_dpp v27, v27, v27 row_ror:4 row_mask:0xf bank_mask:0xf
    s_nop 1
    v_add_f32_dpp v26, v26, v26 row_ror:2 row_mask:0xf bank_mask:0xf
    v_add_f32_dpp v27, v27, v27 row_ror:2 row_mask:0xf bank_mask:0xf
    s_nop 1
    v_add_f32_dpp v26, v26, v26 row_ror:1 row_mask:0xf bank_mask:0xf
    v_add_f32_dpp v27, v27, v27 row_ror:1 row_mask:0xf bank_mask:0xf
    s_mov_b32 s52, 0x3ae38e39
    v_mul_f32 v26, s52, v26
    v_cvt_pk_bf16_f32 v14, v26, v26
    v_and_b32 v14, 0xffff0000, v14
    v_sub_f32 v26, v26, v14
    v_cndmask_b32 v14, 0, v14, s[36:37]
    v_mul_f32 v27, s52, v27
    v_cvt_pk_bf16_f32 v16, v27, v27
    v_and_b32 v16, 0xffff0000, v16
    v_sub_f32 v27, v27, v16
    v_cndmask_b32 v16, 0, v16, s[40:41]
    v_pk_add_f32 v[32:33], v[32:33], v[14:15] op_sel_hi:[1,0] neg_lo:[0,1] neg_hi:[0,1]
    v_pk_add_f32 v[80:81], v[80:81], v[16:17] op_sel_hi:[1,0] neg_lo:[0,1] neg_hi:[0,1]
    v_pk_add_f32 v[34:35], v[34:35], v[14:15] op_sel_hi:[1,0] neg_lo:[0,1] neg_hi:[0,1]
    v_pk_add_f32 v[82:83], v[82:83], v[16:17] op_sel_hi:[1,0] neg_lo:[0,1] neg_hi:[0,1]
    v_pk_add_f32 v[36:37], v[36:37], v[14:15] op_sel_hi:[1,0] neg_lo:[0,1] neg_hi:[0,1]
    v_pk_add_f32 v[84:85], v[84:85], v[16:17] op_sel_hi:[1,0] neg_lo:[0,1] neg_hi:[0,1]
    v_pk_add_f32 v[38:39], v[38:39], v[14:15] op_sel_hi:[1,0] neg_lo:[0,1] neg_hi:[0,1]
    v_pk_add_f32 v[86:87], v[86:87], v[16:17] op_sel_hi:[1,0] neg_lo:[0,1] neg_hi:[0,1]
    v_pk_add_f32 v[40:41], v[40:41], v[14:15] op_sel_hi:[1,0] neg_lo:[0,1] neg_hi:[0,1]
    v_pk_add_f32 v[88:89], v[88:89], v[16:17] op_sel_hi:[1,0] neg_lo:[0,1] neg_hi:[0,1]
    v_pk_add_f32 v[42:43], v[42:43], v[14:15] op_sel_hi:[1,0] neg_lo:[0,1] neg_hi:[0,1]
    v_pk_add_f32 v[90:91], v[90:91], v[16:17] op_sel_hi:[1,0] neg_lo:[0,1] neg_hi:[0,1]
    v_pk_add_f32 v[44:45], v[44:45], v[14:15] op_sel_hi:[1,0] neg_lo:[0,1] neg_hi:[0,1]
    v_pk_add_f32 v[92:93], v[92:93], v[16:17] op_sel_hi:[1,0] neg_lo:[0,1] neg_hi:[0,1]
    v_pk_add_f32 v[46:47], v[46:47], v[14:15] op_sel_hi:[1,0] neg_lo:[0,1] neg_hi:[0,1]
    v_pk_add_f32 v[94:95], v[94:95], v[16:17] op_sel_hi:[1,0] neg_lo:[0,1] neg_hi:[0,1]
    v_pk_add_f32 v[48:49], v[48:49], v[14:15] op_sel_hi:[1,0] neg_lo:[0,1] neg_hi:[0,1]
    v_pk_add_f32 v[96:97], v[96:97], v[16:17] op_sel_hi:[1,0] neg_lo:[0,1] neg_hi:[0,1]
    v_pk_add_f32 v[50:51], v[50:51], v[14:15] op_sel_hi:[1,0] neg_lo:[0,1] neg_hi:[0,1]
    v_pk_add_f32 v[98:99], v[98:99], v[16:17] op_sel_hi:[1,0] neg_lo:[0,1] neg_hi:[0,1]
    v_pk_add_f32 v[52:53], v[52:53], v[14:15] op_sel_hi:[1,0] neg_lo:[0,1] neg_hi:[0,1]
    v_pk_add_f32 v[100:101], v[100:101], v[16:17] op_sel_hi:[1,0] neg_lo:[0,1] neg_hi:[0,1]
    v_pk_add_f32 v[54:55], v[54:55], v[14:15] op_sel_hi:[1,0] neg_lo:[0,1] neg_hi:[0,1]
    v_pk_add_f32 v[102:103], v[102:103], v[16:17] op_sel_hi:[1,0] neg_lo:[0,1] neg_hi:[0,1]
    v_pk_add_f32 v[56:57], v[56:57], v[14:15] op_sel_hi:[1,0] neg_lo:[0,1] neg_hi:[0,1]
    v_pk_add_f32 v[104:105], v[104:105], v[16:17] op_sel_hi:[1,0] neg_lo:[0,1] neg_hi:[0,1]
    v_pk_add_f32 v[58:59], v[58:59], v[14:15] op_sel_hi:[1,0] neg_lo:[0,1] neg_hi:[0,1]
    v_pk_add_f32 v[106:107], v[106:107], v[16:17] op_sel_hi:[1,0] neg_lo:[0,1] neg_hi:[0,1]
    v_pk_add_f32 v[60:61], v[60:61], v[14:15] op_sel_hi:[1,0] neg_lo:[0,1] neg_hi:[0,1]
    v_pk_add_f32 v[108:109], v[108:109], v[16:17] op_sel_hi:[1,0] neg_lo:[0,1] neg_hi:[0,1]
    v_pk_add_f32 v[62:63], v[62:63], v[14:15] op_sel_hi:[1,0] neg_lo:[0,1] neg_hi:[0,1]
    v_pk_add_f32 v[110:111], v[110:111], v[16:17] op_sel_hi:[1,0] neg_lo:[0,1] neg_hi:[0,1]
    v_pk_add_f32 v[64:65], v[64:65], v[14:15] op_sel_hi:[1,0] neg_lo:[0,1] neg_hi:[0,1]
    v_pk_add_f32 v[112:113], v[112:113], v[16:17] op_sel_hi:[1,0] neg_lo:[0,1] neg_hi:[0,1]
    v_pk_add_f32 v[66:67], v[66:67], v[14:15] op_sel_hi:[1,0] neg_lo:[0,1] neg_hi:[0,1]
    v_pk_add_f32 v[114:115], v[114:115], v[16:17] op_sel_hi:[1,0] neg_lo:[0,1] neg_hi:[0,1]
    v_pk_add_f32 v[68:69], v[68:69], v[14:15] op_sel_hi:[1,0] neg_lo:[0,1] neg_hi:[0,1]
    v_pk_add_f32 v[116:117], v[116:117], v[16:17] op_sel_hi:[1,0] neg_lo:[0,1] neg_hi:[0,1]
    v_pk_add_f32 v[70:71], v[70:71], v[14:15] op_sel_hi:[1,0] neg_lo:[0,1] neg_hi:[0,1]
    v_pk_add_f32 v[118:119], v[118:119], v[16:17] op_sel_hi:[1,0] neg_lo:[0,1] neg_hi:[0,1]
    v_pk_add_f32 v[72:73], v[72:73], v[14:15] op_sel_hi:[1,0] neg_lo:[0,1] neg_hi:[0,1]
    v_pk_add_f32 v[120:121], v[120:121], v[16:17] op_sel_hi:[1,0] neg_lo:[0,1] neg_hi:[0,1]
    v_pk_add_f32 v[74:75], v[74:75], v[14:15] op_sel_hi:[1,0] neg_lo:[0,1] neg_hi:[0,1]
    v_pk_add_f32 v[122:123], v[122:123], v[16:17] op_sel_hi:[1,0] neg_lo:[0,1] neg_hi:[0,1]
    v_pk_add_f32 v[76:77], v[76:77], v[14:15] op_sel_hi:[1,0] neg_lo:[0,1] neg_hi:[0,1]
    v_pk_add_f32 v[124:125], v[124:125], v[16:17] op_sel_hi:[1,0] neg_lo:[0,1] neg_hi:[0,1]
    v_pk_add_f32 v[78:79], v[78:79], v[14:15] op_sel_hi:[1,0] neg_lo:[0,1] neg_hi:[0,1]
    v_pk_add_f32 v[126:127], v[126:127], v[16:17] op_sel_hi:[1,0] neg_lo:[0,1] neg_hi:[0,1]
    v_pk_mul_f32 v[22:23], v[32:33], v[32:33]
    v_pk_mul_f32 v[24:25], v[80:81], v[80:81]
    v_pk_fma_f32 v[22:23], v[34:35], v[34:35], v[22:23]
    v_pk_fma_f32 v[24:25], v[82:83], v[82:83], v[24:25]
    v_pk_fma_f32 v[22:23], v[36:37], v[36:37], v[22:23]
    v_pk_fma_f32 v[24:25], v[84:85], v[84:85], v[24:25]
    v_pk_fma_f32 v[22:23], v[38:39], v[38:39], v[22:23]
    v_pk_fma_f32 v[24:25], v[86:87], v[86:87], v[24:25]
    v_pk_fma_f32 v[22:23], v[40:41], v[40:41], v[22:23]
    v_pk_fma_f32 v[24:25], v[88:89], v[88:89], v[24:25]
    v_pk_fma_f32 v[22:23], v[42:43], v[42:43], v[22:23]
    v_pk_fma_f32 v[24:25], v[90:91], v[90:91], v[24:25]
    v_pk_fma_f32 v[22:23], v[44:45], v[44:45], v[22:23]
    v_pk_fma_f32 v[24:25], v[92:93], v[92:93], v[24:25]
    v_pk_fma_f32 v[22:23], v[46:47], v[46:47], v[22:23]
    v_pk_fma_f32 v[24:25], v[94:95], v[94:95], v[24:25]
    v_pk_fma_f32 v[22:23], v[48:49], v[48:49], v[22:23]
    v_pk_fma_f32 v[24:25], v[96:97], v[96:97], v[24:25]
    v_pk_fma_f32 v[22:23], v[50:51], v[50:51], v[22:23]
    v_pk_fma_f32 v[24:25], v[98:99], v[98:99], v[24:25]
    v_pk_fma_f32 v[22:23], v[52:53], v[52:53], v[22:23]
    v_pk_fma_f32 v[24:25], v[100:101], v[100:101], v[24:25]
    v_pk_fma_f32 v[22:23], v[54:55], v[54:55], v[22:23]
    v_pk_fma_f32 v[24:25], v[102:103], v[102:103], v[24:25]
    v_pk_fma_f32 v[22:23], v[56:57], v[56:57], v[22:23]
    v_pk_fma_f32 v[24:25], v[104:105], v[104:105], v[24:25]
    v_pk_fma_f32 v[22:23], v[58:59], v[58:59], v[22:23]
    v_pk_fma_f32 v[24:25], v[106:107], v[106:107], v[24:25]
    v_pk_fma_f32 v[22:23], v[60:61], v[60:61], v[22:23]
    v_pk_fma_f32 v[24:25], v[108:109], v[108:109], v[24:25]
    v_pk_fma_f32 v[22:23], v[62:63], v[62:63], v[22:23]
    v_pk_fma_f32 v[24:25], v[110:111], v[110:111], v[24:25]
    v_pk_fma_f32 v[22:23], v[64:65], v[64:65], v[22:23]
    v_pk_fma_f32 v[24:25], v[112:113], v[112:113], v[24:25]
    v_pk_fma_f32 v[22:23], v[66:67], v[66:67], v[22:23]
    v_pk_fma_f32 v[24:25], v[114:115], v[114:115], v[24:25]
    v_pk_fma_f32 v[22:23], v[68:69], v[68:69], v[22:23]
    v_pk_fma_f32 v[24:25], v[116:117], v[116:117], v[24:25]
    v_pk_fma_f32 v[22:23], v[70:71], v[70:71], v[22:23]
    v_pk_fma_f32 v[24:25], v[118:119], v[118:119], v[24:25]
    v_pk_fma_f32 v[22:23], v[72:73], v[72:73], v[22:23]
    v_pk_fma_f32 v[24:25], v[120:121], v[120:121], v[24:25]
    v_pk_fma_f32 v[22:23], v[74:75], v[74:75], v[22:23]
    v_pk_fma_f32 v[24:25], v[122:123], v[122:123], v[24:25]
    v_pk_fma_f32 v[22:23], v[76:77], v[76:77], v[22:23]
    v_pk_fma_f32 v[24:25], v[124:125], v[124:125], v[24:25]
    v_pk_fma_f32 v[22:23], v[78:79], v[78:79], v[22:23]
    v_pk_fma_f32 v[24:25], v[126:127], v[126:127], v[24:25]
    v_add_f32 v18, v22, v23
    v_add_f32 v20, v24, v25
    s_nop 1
    v_add_f32_dpp v18, v18, v18 row_ror:8 row_mask:0xf bank_mask:0xf
    v_add_f32_dpp v20, v20, v20 row_ror:8 row_mask:0xf bank_mask:0xf
    s_nop 1
    v_add_f32_dpp v18, v18, v18 row_ror:4 row_mask:0xf bank_mask:0xf
    v_add_f32_dpp v20, v20, v20 row_ror:4 row_mask:0xf bank_mask:0xf
    s_nop 1
    v_add_f32_dpp v18, v18, v18 row_ror:2 row_mask:0xf bank_mask:0xf
    v_add_f32_dpp v20, v20, v20 row_ror:2 row_mask:0xf bank_mask:0xf
    s_nop 1
    v_add_f32_dpp v18, v18, v18 row_ror:1 row_mask:0xf bank_mask:0xf
    v_add_f32_dpp v20, v20, v20 row_ror:1 row_mask:0xf bank_mask:0xf
    s_mov_b32 s53, 0x3727c5ac
    v_mul_f32 v18, s52, v18
    v_fma_f32 v18, -v26, v26, v18
    v_max_f32 v18, 0, v18
    v_cvt_pk_bf16_f32 v18, v18, v18
    v_and_b32 v18, 0xffff0000, v18
    v_add_f32 v18, s53, v18
    v_cvt_pk_bf16_f32 v18, v18, v18
    v_and_b32 v18, 0xffff0000, v18
    v_sqrt_f32 v18, v18
    s_nop 0
    v_cvt_pk_bf16_f32 v18, v18, v18
    v_and_b32 v18, 0xffff0000, v18
    v_rcp_f32 v18, v18
    v_mul_f32 v20, s52, v20
    v_fma_f32 v20, -v27, v27, v20
    v_max_f32 v20, 0, v20
    v_cvt_pk_bf16_f32 v20, v20, v20
    v_and_b32 v20, 0xffff0000, v20
    v_add_f32 v20, s53, v20
    v_cvt_pk_bf16_f32 v20, v20, v20
    v_and_b32 v20, 0xffff0000, v20
    v_sqrt_f32 v20, v20
    s_nop 0
    v_cvt_pk_bf16_f32 v20, v20, v20
    v_and_b32 v20, 0xffff0000, v20
    v_rcp_f32 v20, v20
    v_cndmask_b32 v28, 1.0, 2.0, s[38:39]
    s_mov_b32 s54, -2.0
    s_mov_b32 s55, -2.0
    v_pk_mul_f32 v[80:81], v[80:81], v[20:21] op_sel_hi:[1,0]
    v_pk_fma_f32 v[32:33], v[32:33], v[18:19], v[80:81] op_sel_hi:[1,0,1]
    v_pk_fma_f32 v[80:81], v[80:81], s[54:55], v[32:33]
    v_pk_mul_f32 v[82:83], v[82:83], v[20:21] op_sel_hi:[1,0]
    v_pk_fma_f32 v[34:35], v[34:35], v[18:19], v[82:83] op_sel_hi:[1,0,1]
    v_pk_fma_f32 v[82:83], v[82:83], s[54:55], v[34:35]
    v_pk_mul_f32 v[84:85], v[84:85], v[20:21] op_sel_hi:[1,0]
    v_pk_fma_f32 v[36:37], v[36:37], v[18:19], v[84:85] op_sel_hi:[1,0,1]
    v_pk_fma_f32 v[84:85], v[84:85], s[54:55], v[36:37]
    v_pk_mul_f32 v[86:87], v[86:87], v[20:21] op_sel_hi:[1,0]
    v_pk_fma_f32 v[38:39], v[38:39], v[18:19], v[86:87] op_sel_hi:[1,0,1]
    v_pk_fma_f32 v[86:87], v[86:87], s[54:55], v[38:39]
    v_pk_mul_f32 v[88:89], v[88:89], v[20:21] op_sel_hi:[1,0]
    v_pk_fma_f32 v[40:41], v[40:41], v[18:19], v[88:89] op_sel_hi:[1,0,1]
    v_pk_fma_f32 v[88:89], v[88:89], s[54:55], v[40:41]
    v_pk_mul_f32 v[90:91], v[90:91], v[20:21] op_sel_hi:[1,0]
    v_pk_fma_f32 v[42:43], v[42:43], v[18:19], v[90:91] op_sel_hi:[1,0,1]
    v_pk_fma_f32 v[90:91], v[90:91], s[54:55], v[42:43]
    v_pk_mul_f32 v[92:93], v[92:93], v[20:21] op_sel_hi:[1,0]
    v_pk_fma_f32 v[44:45], v[44:45], v[18:19], v[92:93] op_sel_hi:[1,0,1]
    v_pk_fma_f32 v[92:93], v[92:93], s[54:55], v[44:45]
    v_pk_mul_f32 v[94:95], v[94:95], v[20:21] op_sel_hi:[1,0]
    v_pk_fma_f32 v[46:47], v[46:47], v[18:19], v[94:95] op_sel_hi:[1,0,1]
    v_pk_fma_f32 v[94:95], v[94:95], s[54:55], v[46:47]
    v_pk_mul_f32 v[96:97], v[96:97], v[20:21] op_sel_hi:[1,0]
    v_pk_fma_f32 v[48:49], v[48:49], v[18:19], v[96:97] op_sel_hi:[1,0,1]
    v_pk_fma_f32 v[96:97], v[96:97], s[54:55], v[48:49]
    v_pk_mul_f32 v[98:99], v[98:99], v[20:21] op_sel_hi:[1,0]
    v_pk_fma_f32 v[50:51], v[50:51], v[18:19], v[98:99] op_sel_hi:[1,0,1]
    v_pk_fma_f32 v[98:99], v[98:99], s[54:55], v[50:51]
    v_pk_mul_f32 v[100:101], v[100:101], v[20:21] op_sel_hi:[1,0]
    v_pk_fma_f32 v[52:53], v[52:53], v[18:19], v[100:101] op_sel_hi:[1,0,1]
    v_pk_fma_f32 v[100:101], v[100:101], s[54:55], v[52:53]
    v_pk_mul_f32 v[102:103], v[102:103], v[20:21] op_sel_hi:[1,0]
    v_pk_fma_f32 v[54:55], v[54:55], v[18:19], v[102:103] op_sel_hi:[1,0,1]
    v_pk_fma_f32 v[102:103], v[102:103], s[54:55], v[54:55]
    v_pk_mul_f32 v[104:105], v[104:105], v[20:21] op_sel_hi:[1,0]
    v_pk_fma_f32 v[56:57], v[56:57], v[18:19], v[104:105] op_sel_hi:[1,0,1]
    v_pk_fma_f32 v[104:105], v[104:105], s[54:55], v[56:57]
    v_pk_mul_f32 v[106:107], v[106:107], v[20:21] op_sel_hi:[1,0]
    v_pk_fma_f32 v[58:59], v[58:59], v[18:19], v[106:107] op_sel_hi:[1,0,1]
    v_pk_fma_f32 v[106:107], v[106:107], s[54:55], v[58:59]
    v_pk_mul_f32 v[108:109], v[108:109], v[20:21] op_sel_hi:[1,0]
    v_pk_fma_f32 v[60:61], v[60:61], v[18:19], v[108:109] op_sel_hi:[1,0,1]
    v_pk_fma_f32 v[108:109], v[108:109], s[54:55], v[60:61]
    v_pk_mul_f32 v[110:111], v[110:111], v[20:21] op_sel_hi:[1,0]
    v_pk_fma_f32 v[62:63], v[62:63], v[18:19], v[110:111] op_sel_hi:[1,0,1]
    v_pk_fma_f32 v[110:111], v[110:111], s[54:55], v[62:63]
    v_pk_mul_f32 v[112:113], v[112:113], v[20:21] op_sel_hi:[1,0]
    v_pk_fma_f32 v[64:65], v[64:65], v[18:19], v[112:113] op_sel_hi:[1,0,1]
    v_pk_fma_f32 v[112:113], v[112:113], s[54:55], v[64:65]
    v_pk_mul_f32 v[114:115], v[114:115], v[20:21] op_sel_hi:[1,0]
    v_pk_fma_f32 v[66:67], v[66:67], v[18:19], v[114:115] op_sel_hi:[1,0,1]
    v_pk_fma_f32 v[114:115], v[114:115], s[54:55], v[66:67]
    v_pk_mul_f32 v[116:117], v[116:117], v[20:21] op_sel_hi:[1,0]
    v_pk_fma_f32 v[68:69], v[68:69], v[18:19], v[116:117] op_sel_hi:[1,0,1]
    v_pk_fma_f32 v[116:117], v[116:117], s[54:55], v[68:69]
    v_pk_mul_f32 v[118:119], v[118:119], v[20:21] op_sel_hi:[1,0]
    v_pk_fma_f32 v[70:71], v[70:71], v[18:19], v[118:119] op_sel_hi:[1,0,1]
    v_pk_fma_f32 v[118:119], v[118:119], s[54:55], v[70:71]
    v_pk_mul_f32 v[120:121], v[120:121], v[20:21] op_sel_hi:[1,0]
    v_pk_fma_f32 v[72:73], v[72:73], v[18:19], v[120:121] op_sel_hi:[1,0,1]
    v_pk_fma_f32 v[120:121], v[120:121], s[54:55], v[72:73]
    v_pk_mul_f32 v[122:123], v[122:123], v[20:21] op_sel_hi:[1,0]
    v_pk_fma_f32 v[74:75], v[74:75], v[18:19], v[122:123] op_sel_hi:[1,0,1]
    v_pk_fma_f32 v[122:123], v[122:123], s[54:55], v[74:75]
    v_pk_mul_f32 v[124:125], v[124:125], v[20:21] op_sel_hi:[1,0]
    v_pk_fma_f32 v[76:77], v[76:77], v[18:19], v[124:125] op_sel_hi:[1,0,1]
    v_pk_fma_f32 v[124:125], v[124:125], s[54:55], v[76:77]
    v_pk_mul_f32 v[126:127], v[126:127], v[20:21] op_sel_hi:[1,0]
    v_pk_fma_f32 v[78:79], v[78:79], v[18:19], v[126:127] op_sel_hi:[1,0,1]
    v_pk_fma_f32 v[126:127], v[126:127], s[54:55], v[78:79]
    s_barrier
    ds_read_b128 v[128:131], v8 offset:2304
    ds_read_b128 v[152:155], v9 offset:2304
    ds_read_b128 v[176:179], v8 offset:0
    ds_read_b128 v[200:203], v9 offset:0
    ds_read_b128 v[132:135], v8 offset:2320
    ds_read_b128 v[156:159], v9 offset:2320
    ds_read_b128 v[180:183], v8 offset:16
    ds_read_b128 v[204:207], v9 offset:16
    s_nop 1
    v_mov_b32 v4, 0
    v_mov_b32_dpp v5, v62 row_shl:11 row_mask:0xf bank_mask:0xf bound_ctrl:0
    v_mov_b32_dpp v6, v70 row_shl:11 row_mask:0xf bank_mask:0xf bound_ctrl:0
    s_nop 1
    v_mov_b32_dpp v4, v62 row_shr:1 row_mask:0xf bank_mask:0xf
    v_mov_b32_dpp v5, v70 row_shr:1 row_mask:0xf bank_mask:0xf
    v_mov_b32_dpp v6, v78 row_shr:1 row_mask:0xf bank_mask:0xf
    v_mov_b32 v62, v4
    v_mov_b32 v70, v5
    v_mov_b32 v78, v6
    s_nop 1
    v_mov_b32 v4, 0
    v_mov_b32_dpp v5, v110 row_shl:11 row_mask:0xf bank_mask:0xf bound_ctrl:0
    v_mov_b32_dpp v6, v118 row_shl:11 row_mask:0xf bank_mask:0xf bound_ctrl:0
    s_nop 1
    v_mov_b32_dpp v4, v110 row_shr:1 row_mask:0xf bank_mask:0xf
    v_mov_b32_dpp v5, v118 row_shr:1 row_mask:0xf bank_mask:0xf
    v_mov_b32_dpp v6, v126 row_shr:1 row_mask:0xf bank_mask:0xf
    v_mov_b32 v110, v4
    v_mov_b32 v118, v5
    v_mov_b32 v126, v6
    v_cmp_eq_u32 vcc, 0, v2
    v_mul_u32_u24 v10, 592, v1
    v_lshl_add_u32 v10, v2, 4, v10
    v_lshlrev_b32 v11, 2, v1
    s_waitcnt lgkmcnt(0)
    ds_read_b128 v[136:139], v8 offset:2688
    ds_read_b128 v[160:163], v9 offset:2688
    ds_read_b128 v[184:187], v8 offset:384
    ds_read_b128 v[208:211], v9 offset:384
    ds_read_b128 v[140:143], v8 offset:2704
    ds_read_b128 v[164:167], v9 offset:2704
    ds_read_b128 v[188:191], v8 offset:400
    ds_read_b128 v[212:215], v9 offset:400
    v_cndmask_b32 v200, v200, 0, vcc
    v_pk_add_f32 v[176:177], v[176:177], v[200:201]
    v_pk_mul_f32 v[176:177], v[176:177], v[28:29] op_sel_hi:[1,0]
    v_pk_fma_f32 v[176:177], v[62:63], v[152:153], v[176:177]
    v_pk_fma_f32 v[176:177], v[32:33], v[128:129], v[176:177]
    v_pk_mul_f32 v[200:201], v[110:111], v[152:153]
    v_pk_fma_f32 v[200:201], v[80:81], v[128:129], v[200:201] neg_lo:[0,0,1] neg_hi:[0,0,1]
    v_pk_add_f32 v[178:179], v[178:179], v[202:203]
    v_pk_mul_f32 v[178:179], v[178:179], v[28:29] op_sel_hi:[1,0]
    v_pk_fma_f32 v[178:179], v[60:61], v[154:155], v[178:179]
    v_pk_fma_f32 v[178:179], v[34:35], v[130:131], v[178:179]
    v_pk_mul_f32 v[202:203], v[108:109], v[154:155]
    v_pk_fma_f32 v[202:203], v[82:83], v[130:131], v[202:203] neg_lo:[0,0,1] neg_hi:[0,0,1]
    v_pk_add_f32 v[180:181], v[180:181], v[204:205]
    v_pk_mul_f32 v[180:181], v[180:181], v[28:29] op_sel_hi:[1,0]
    v_pk_fma_f32 v[180:181], v[58:59], v[156:157], v[180:181]
    v_pk_fma_f32 v[180:181], v[36:37], v[132:133], v[180:181]
    v_pk_mul_f32 v[204:205], v[106:107], v[156:157]
    v_pk_fma_f32 v[204:205], v[84:85], v[132:133], v[204:205] neg_lo:[0,0,1] neg_hi:[0,0,1]
    v_pk_add_f32 v[182:183], v[182:183], v[206:207]
    v_pk_mul_f32 v[182:183], v[182:183], v[28:29] op_sel_hi:[1,0]
    v_pk_fma_f32 v[182:183], v[56:57], v[158:159], v[182:183]
    v_pk_fma_f32 v[182:183], v[38:39], v[134:135], v[182:183]
    v_pk_mul_f32 v[206:207], v[104:105], v[158:159]
    v_pk_fma_f32 v[206:207], v[86:87], v[134:135], v[206:207] neg_lo:[0,0,1] neg_hi:[0,0,1]
    v_cvt_pk_bf16_f32 v128, v176, v177
    v_cvt_pk_bf16_f32 v132, v200, v201
    v_cvt_pk_bf16_f32 v129, v178, v179
    v_cvt_pk_bf16_f32 v133, v202, v203
    v_cvt_pk_bf16_f32 v130, v180, v181
    v_cvt_pk_bf16_f32 v134, v204, v205
    v_cvt_pk_bf16_f32 v131, v182, v183
    v_cvt_pk_bf16_f32 v135, v206, v207
    s_mov_b64 exec, s[32:33]
    ds_write_b128 v10, v[128:131] offset:0
    ds_write_b128 v10, v[132:135] offset:9472
    s_mov_b64 exec, -1
    s_waitcnt lgkmcnt(2)
    ds_read_b128 v[144:147], v8 offset:3072
    ds_read_b128 v[168:171], v9 offset:3072
    ds_read_b128 v[192:195], v8 offset:768
    ds_read_b128 v[216:219], v9 offset:768
    ds_read_b128 v[148:151], v8 offset:3088
    ds_read_b128 v[172:175], v9 offset:3088
    ds_read_b128 v[196:199], v8 offset:784
    ds_read_b128 v[220:223], v9 offset:784
    v_pk_add_f32 v[184:185], v[184:185], v[208:209]
    v_pk_mul_f32 v[184:185], v[184:185], v[28:29] op_sel_hi:[1,0]
    v_pk_fma_f32 v[184:185], v[70:71], v[160:161], v[184:185]
    v_pk_fma_f32 v[184:185], v[40:41], v[136:137], v[184:185]
    v_pk_mul_f32 v[208:209], v[118:119], v[160:161]
    v_pk_fma_f32 v[208:209], v[88:89], v[136:137], v[208:209] neg_lo:[0,0,1] neg_hi:[0,0,1]
    v_pk_add_f32 v[186:187], v[186:187], v[210:211]
    v_pk_mul_f32 v[186:187], v[186:187], v[28:29] op_sel_hi:[1,0]
    v_pk_fma_f32 v[186:187], v[68:69], v[162:163], v[186:187]
    v_pk_fma_f32 v[186:187], v[42:43], v[138:139], v[186:187]
    v_pk_mul_f32 v[210:211], v[116:117], v[162:163]
    v_pk_fma_f32 v[210:211], v[90:91], v[138:139], v[210:211] neg_lo:[0,0,1] neg_hi:[0,0,1]
    v_pk_add_f32 v[188:189], v[188:189], v[212:213]
    v_pk_mul_f32 v[188:189], v[188:189], v[28:29] op_sel_hi:[1,0]
    v_pk_fma_f32 v[188:189], v[66:67], v[164:165], v[188:189]
    v_pk_fma_f32 v[188:189], v[44:45], v[140:141], v[188:189]
    v_pk_mul_f32 v[212:213], v[114:115], v[164:165]
    v_pk_fma_f32 v[212:213], v[92:93], v[140:141], v[212:213] neg_lo:[0,0,1] neg_hi:[0,0,1]
    v_pk_add_f32 v[190:191], v[190:191], v[214:215]
    v_pk_mul_f32 v[190:191], v[190:191], v[28:29] op_sel_hi:[1,0]
    v_pk_fma_f32 v[190:191], v[64:65], v[166:167], v[190:191]
    v_pk_fma_f32 v[190:191], v[46:47], v[142:143], v[190:191]
    v_pk_mul_f32 v[214:215], v[112:113], v[166:167]
    v_pk_fma_f32 v[214:215], v[94:95], v[142:143], v[214:215] neg_lo:[0,0,1] neg_hi:[0,0,1]
    v_cvt_pk_bf16_f32 v136, v184, v185
    v_cvt_pk_bf16_f32 v140, v208, v209
    v_cvt_pk_bf16_f32 v137, v186, v187
    v_cvt_pk_bf16_f32 v141, v210, v211
    v_cvt_pk_bf16_f32 v138, v188, v189
    v_cvt_pk_bf16_f32 v142, v212, v213
    v_cvt_pk_bf16_f32 v139, v190, v191
    v_cvt_pk_bf16_f32 v143, v214, v215
    s_mov_b64 exec, s[32:33]
    ds_write_b128 v10, v[136:139] offset:192
    ds_write_b128 v10, v[140:143] offset:9664
    s_mov_b64 exec, -1
    s_waitcnt lgkmcnt(2)
    v_cndmask_b32 v192, v192, 0, s[34:35]
    v_pk_add_f32 v[192:193], v[192:193], v[216:217]
    v_pk_mul_f32 v[192:193], v[192:193], v[28:29] op_sel_hi:[1,0]
    v_pk_fma_f32 v[192:193], v[78:79], v[168:169], v[192:193]
    v_pk_fma_f32 v[192:193], v[48:49], v[144:145], v[192:193]
    v_pk_mul_f32 v[216:217], v[126:127], v[168:169]
    v_pk_fma_f32 v[216:217], v[96:97], v[144:145], v[216:217] neg_lo:[0,0,1] neg_hi:[0,0,1]
    v_pk_add_f32 v[194:195], v[194:195], v[218:219]
    v_pk_mul_f32 v[194:195], v[194:195], v[28:29] op_sel_hi:[1,0]
    v_pk_fma_f32 v[194:195], v[76:77], v[170:171], v[194:195]
    v_pk_fma_f32 v[194:195], v[50:51], v[146:147], v[194:195]
    v_pk_mul_f32 v[218:219], v[124:125], v[170:171]
    v_pk_fma_f32 v[218:219], v[98:99], v[146:147], v[218:219] neg_lo:[0,0,1] neg_hi:[0,0,1]
    v_pk_add_f32 v[196:197], v[196:197], v[220:221]
    v_pk_mul_f32 v[196:197], v[196:197], v[28:29] op_sel_hi:[1,0]
    v_pk_fma_f32 v[196:197], v[74:75], v[172:173], v[196:197]
    v_pk_fma_f32 v[196:197], v[52:53], v[148:149], v[196:197]
    v_pk_mul_f32 v[220:221], v[122:123], v[172:173]
    v_pk_fma_f32 v[220:221], v[100:101], v[148:149], v[220:221] neg_lo:[0,0,1] neg_hi:[0,0,1]
    v_pk_add_f32 v[198:199], v[198:199], v[222:223]
    v_pk_mul_f32 v[198:199], v[198:199], v[28:29] op_sel_hi:[1,0]
    v_pk_fma_f32 v[198:199], v[72:73], v[174:175], v[198:199]
    v_pk_fma_f32 v[198:199], v[54:55], v[150:151], v[198:199]
    v_pk_mul_f32 v[222:223], v[120:121], v[174:175]
    v_pk_fma_f32 v[222:223], v[102:103], v[150:151], v[222:223] neg_lo:[0,0,1] neg_hi:[0,0,1]
    v_cvt_pk_bf16_f32 v144, v192, v193
    v_cvt_pk_bf16_f32 v148, v216, v217
    v_cvt_pk_bf16_f32 v145, v194, v195
    v_cvt_pk_bf16_f32 v149, v218, v219
    v_cvt_pk_bf16_f32 v146, v196, v197
    v_cvt_pk_bf16_f32 v150, v220, v221
    v_cvt_pk_bf16_f32 v147, v198, v199
    v_cvt_pk_bf16_f32 v151, v222, v223
    s_mov_b64 exec, s[32:33]
    ds_write_b128 v10, v[144:147] offset:384
    ds_write_b128 v10, v[148:151] offset:9856
    s_mov_b64 exec, s[34:35]
    ds_write_b32 v11, v192 offset:18944
    s_mov_b64 exec, -1
    s_waitcnt lgkmcnt(0)
    s_barrier
    s_endpgm
k2_mf_17:
    s_sub_u32 s30, s30, 4
    s_and_b32 s49, s30, 1
    s_mul_i32 s49, s49, 5
    s_mul_i32 s50, s29, 9
    s_add_u32 s49, s49, s50
    s_mul_i32 s50, s49, 18432
    s_mul_i32 s31, s30, 27648
    s_add_u32 s31, s31, 24576
    s_movk_i32 s32, 1821
    s_waitcnt lgkmcnt(0)
    s_cmp_lt_u32 s30, 2
    s_cselect_b32 s44, s12, s20
    s_cselect_b32 s45, s13, s21
    s_mov_b32 s46, 663552
    s_mov_b32 s47, 0x00020000
    s_cselect_b32 s48, -1, 0
    v_and_b32 v26, 255, v0
    v_lshlrev_b32 v26, 4, v26
    v_add_u32 v27, 4096, v26
    v_min_u32 v27, 4592, v27
    s_mov_b32 s33, 32768
    s_barrier
    s_setprio 3
    v_add_u32 v10, 0, v12
    v_mul_u32_u24 v11, s32, v10
    v_lshrrev_b32 v11, 16, v11
    v_mul_u32_u24 v16, 576, v11
    v_lshl_add_u32 v16, v10, 4, v16
    s_add_u32 m0, s31, 0
    s_nop 0
    buffer_load_dwordx4 v16, s[44:47], s50 offen lds
    v_add_u32 v10, 64, v12
    v_mul_u32_u24 v11, s32, v10
    v_lshrrev_b32 v11, 16, v11
    v_mul_u32_u24 v17, 576, v11
    v_lshl_add_u32 v17, v10, 4, v17
    s_add_u32 m0, s31, 1024
    s_nop 0
    buffer_load_dwordx4 v17, s[44:47], s50 offen lds
    v_add_u32 v10, 128, v12
    v_mul_u32_u24 v11, s32, v10
    v_lshrrev_b32 v11, 16, v11
    v_mul_u32_u24 v18, 576, v11
    v_lshl_add_u32 v18, v10, 4, v18
    s_add_u32 m0, s31, 2048
    s_nop 0
    buffer_load_dwordx4 v18, s[44:47], s50 offen lds
    v_add_u32 v10, 192, v12
    v_mul_u32_u24 v11, s32, v10
    v_lshrrev_b32 v11, 16, v11
    v_mul_u32_u24 v19, 576, v11
    v_lshl_add_u32 v19, v10, 4, v19
    s_add_u32 m0, s31, 3072
    s_nop 0
    buffer_load_dwordx4 v19, s[44:47], s50 offen lds
    v_add_u32 v10, 256, v12
    v_mul_u32_u24 v11, s32, v10
    v_lshrrev_b32 v11, 16, v11
    v_mul_u32_u24 v20, 576, v11
    v_lshl_add_u32 v20, v10, 4, v20
    s_add_u32 m0, s31, 4096
    s_nop 0
    buffer_load_dwordx4 v20, s[44:47], s50 offen lds
    v_add_u32 v10, 320, v12
    v_mul_u32_u24 v11, s32, v10
    v_lshrrev_b32 v11, 16, v11
    v_mul_u32_u24 v21, 576, v11
    v_lshl_add_u32 v21, v10, 4, v21
    s_add_u32 m0, s31, 5120
    s_nop 0
    buffer_load_dwordx4 v21, s[44:47], s50 offen lds
    v_add_u32 v10, 384, v12
    v_mul_u32_u24 v11, s32, v10
    v_lshrrev_b32 v11, 16, v11
    v_mul_u32_u24 v22, 576, v11
    v_lshl_add_u32 v22, v10, 4, v22
    s_add_u32 m0, s31, 6144
    s_nop 0
    buffer_load_dwordx4 v22, s[44:47], s50 offen lds
    v_add_u32 v10, 448, v12
    v_mul_u32_u24 v11, s32, v10
    v_lshrrev_b32 v11, 16, v11
    v_mul_u32_u24 v23, 576, v11
    v_lshl_add_u32 v23, v10, 4, v23
    s_add_u32 m0, s31, 7168
    s_nop 0
    buffer_load_dwordx4 v23, s[44:47], s50 offen lds
    v_add_u32 v10, 512, v12
    v_mul_u32_u24 v11, s32, v10
    v_lshrrev_b32 v11, 16, v11
    v_mul_u32_u24 v24, 576, v11
    v_lshl_add_u32 v24, v10, 4, v24
    s_add_u32 m0, s31, 8192
    s_nop 0
    buffer_load_dwordx4 v24, s[44:47], s50 offen lds
    s_add_u32 s50, s50, 18432
    s_add_u32 m0, s31, 9216
    s_nop 0
    buffer_load_dwordx4 v16, s[44:47], s50 offen lds
    s_add_u32 m0, s31, 10240
    s_nop 0
    buffer_load_dwordx4 v17, s[44:47], s50 offen lds
    s_add_u32 m0, s31, 11264
    s_nop 0
    buffer_load_dwordx4 v18, s[44:47], s50 offen lds
    s_add_u32 m0, s31, 12288
    s_nop 0
    buffer_load_dwordx4 v19, s[44:47], s50 offen lds
    s_add_u32 m0, s31, 13312
    s_nop 0
    buffer_load_dwordx4 v20, s[44:47], s50 offen lds
    s_add_u32 m0, s31, 14336
    s_nop 0
    buffer_load_dwordx4 v21, s[44:47], s50 offen lds
    s_add_u32 m0, s31, 15360
    s_nop 0
    buffer_load_dwordx4 v22, s[44:47], s50 offen lds
    s_add_u32 m0, s31, 16384
    s_nop 0
    buffer_load_dwordx4 v23, s[44:47], s50 offen lds
    s_add_u32 m0, s31, 17408
    s_nop 0
    buffer_load_dwordx4 v24, s[44:47], s50 offen lds
    s_add_u32 s50, s50, 18432
    s_add_u32 m0, s31, 18432
    s_nop 0
    buffer_load_dwordx4 v16, s[44:47], s50 offen lds
    s_add_u32 m0, s31, 19456
    s_nop 0
    buffer_load_dwordx4 v17, s[44:47], s50 offen lds
    s_add_u32 m0, s31, 20480
    s_nop 0
    buffer_load_dwordx4 v18, s[44:47], s50 offen lds
    s_add_u32 m0, s31, 21504
    s_nop 0
    buffer_load_dwordx4 v19, s[44:47], s50 offen lds
    s_add_u32 m0, s31, 22528
    s_nop 0
    buffer_load_dwordx4 v20, s[44:47], s50 offen lds
    s_add_u32 m0, s31, 23552
    s_nop 0
    buffer_load_dwordx4 v21, s[44:47], s50 offen lds
    s_add_u32 m0, s31, 24576
    s_nop 0
    buffer_load_dwordx4 v22, s[44:47], s50 offen lds
    s_add_u32 m0, s31, 25600
    s_nop 0
    buffer_load_dwordx4 v23, s[44:47], s50 offen lds
    s_add_u32 m0, s31, 26624
    s_nop 0
    buffer_load_dwordx4 v24, s[44:47], s50 offen lds
    v_and_b32 v10, 15, v12
    v_lshrrev_b32 v11, 4, v12
    v_mul_u32_u24 v13, 576, v10
    v_lshl_add_u32 v13, v11, 4, v13
    v_add_u32 v13, s31, v13
    s_waitcnt vmcnt(18)
    ds_read_b128 v[56:59], v13 offset:0
    ds_read_b128 v[60:63], v13 offset:64
    ds_read_b128 v[64:67], v13 offset:128
    ds_read_b128 v[68:71], v13 offset:192
    ds_read_b128 v[72:75], v13 offset:256
    ds_read_b128 v[76:79], v13 offset:320
    ds_read_b128 v[80:83], v13 offset:384
    ds_read_b128 v[84:87], v13 offset:448
    ds_read_b128 v[88:91], v13 offset:512
    s_add_u32 s50, s50, 18432
    s_waitcnt lgkmcnt(0)
    s_add_u32 m0, s31, 0
    s_nop 0
    buffer_load_dwordx4 v16, s[44:47], s50 offen lds
    s_add_u32 m0, s31, 1024
    s_nop 0
    buffer_load_dwordx4 v17, s[44:47], s50 offen lds
    s_add_u32 m0, s31, 2048
    s_nop 0
    buffer_load_dwordx4 v18, s[44:47], s50 offen lds
    s_add_u32 m0, s31, 3072
    s_nop 0
    buffer_load_dwordx4 v19, s[44:47], s50 offen lds
    s_add_u32 m0, s31, 4096
    s_nop 0
    buffer_load_dwordx4 v20, s[44:47], s50 offen lds
    s_add_u32 m0, s31, 5120
    s_nop 0
    buffer_load_dwordx4 v21, s[44:47], s50 offen lds
    s_add_u32 m0, s31, 6144
    s_nop 0
    buffer_load_dwordx4 v22, s[44:47], s50 offen lds
    s_add_u32 m0, s31, 7168
    s_nop 0
    buffer_load_dwordx4 v23, s[44:47], s50 offen lds
    s_add_u32 m0, s31, 8192
    s_nop 0
    buffer_load_dwordx4 v24, s[44:47], s50 offen lds
    s_waitcnt vmcnt(18)
    ds_read_b128 v[92:95], v13 offset:9216
    ds_read_b128 v[96:99], v13 offset:9280
    ds_read_b128 v[100:103], v13 offset:9344
    ds_read_b128 v[104:107], v13 offset:9408
    ds_read_b128 v[108:111], v13 offset:9472
    ds_read_b128 v[112:115], v13 offset:9536
    ds_read_b128 v[116:119], v13 offset:9600
    ds_read_b128 v[120:123], v13 offset:9664
    ds_read_b128 v[124:127], v13 offset:9728
    s_add_u32 s50, s50, 18432
    s_waitcnt lgkmcnt(0)
    s_add_u32 m0, s31, 9216
    s_nop 0
    buffer_load_dwordx4 v16, s[44:47], s50 offen lds
    s_add_u32 m0, s31, 10240
    s_nop 0
    buffer_load_dwordx4 v17, s[44:47], s50 offen lds
    s_add_u32 m0, s31, 11264
    s_nop 0
    buffer_load_dwordx4 v18, s[44:47], s50 offen lds
    s_add_u32 m0, s31, 12288
    s_nop 0
    buffer_load_dwordx4 v19, s[44:47], s50 offen lds
    s_add_u32 m0, s31, 13312
    s_nop 0
    buffer_load_dwordx4 v20, s[44:47], s50 offen lds
    s_add_u32 m0, s31, 14336
    s_nop 0
    buffer_load_dwordx4 v21, s[44:47], s50 offen lds
    s_add_u32 m0, s31, 15360
    s_nop 0
    buffer_load_dwordx4 v22, s[44:47], s50 offen lds
    s_add_u32 m0, s31, 16384
    s_nop 0
    buffer_load_dwordx4 v23, s[44:47], s50 offen lds
    s_add_u32 m0, s31, 17408
    s_nop 0
    buffer_load_dwordx4 v24, s[44:47], s50 offen lds
    s_cmp_lg_u32 s30, 0
    s_cbranch_scc1 k2_q_18
    buffer_load_dwordx4 v[168:171], v27, s[16:19], s33 offen
    s_add_u32 s33, s33, 4608
    buffer_load_dwordx4 v[176:179], v27, s[16:19], s33 offen
    s_add_u32 s33, s33, 4608
    buffer_load_dwordx4 v[184:187], v27, s[16:19], s33 offen
    s_add_u32 s33, s33, 4608
    buffer_load_dwordx4 v[192:195], v27, s[16:19], s33 offen
    s_add_u32 s33, s33, 4608
    buffer_load_dwordx4 v[200:203], v27, s[16:19], s33 offen
    s_add_u32 s33, s33, 4608
    buffer_load_dwordx4 v[208:211], v27, s[16:19], s33 offen
    s_add_u32 s33, s33, 4608
    buffer_load_dwordx4 v[216:219], v27, s[16:19], s33 offen
    s_add_u32 s33, s33, 4608
    buffer_load_dwordx4 v[224:227], v27, s[16:19], s33 offen
    s_add_u32 s33, s33, 4608
    s_mov_b32 s33, 32768
k2_q_18:
    buffer_load_dwordx4 v[164:167], v26, s[16:19], s33 offen
    s_add_u32 s33, s33, 4608
    buffer_load_dwordx4 v[172:175], v26, s[16:19], s33 offen
    s_add_u32 s33, s33, 4608
    buffer_load_dwordx4 v[180:183], v26, s[16:19], s33 offen
    s_add_u32 s33, s33, 4608
    buffer_load_dwordx4 v[188:191], v26, s[16:19], s33 offen
    s_add_u32 s33, s33, 4608
    buffer_load_dwordx4 v[196:199], v26, s[16:19], s33 offen
    s_add_u32 s33, s33, 4608
    buffer_load_dwordx4 v[204:207], v26, s[16:19], s33 offen
    s_add_u32 s33, s33, 4608
    buffer_load_dwordx4 v[212:215], v26, s[16:19], s33 offen
    s_add_u32 s33, s33, 4608
    buffer_load_dwordx4 v[220:223], v26, s[16:19], s33 offen
    s_add_u32 s33, s33, 4608
    s_waitcnt vmcnt(0)
    v_pk_add_f32 v[164:165], v[164:165], v[196:197]
    v_pk_add_f32 v[166:167], v[166:167], v[198:199]
    v_pk_add_f32 v[168:169], v[168:169], v[200:201]
    v_pk_add_f32 v[170:171], v[170:171], v[202:203]
    v_pk_add_f32 v[172:173], v[172:173], v[204:205]
    v_pk_add_f32 v[174:175], v[174:175], v[206:207]
    v_pk_add_f32 v[176:177], v[176:177], v[208:209]
    v_pk_add_f32 v[178:179], v[178:179], v[210:211]
    v_pk_add_f32 v[180:181], v[180:181], v[212:213]
    v_pk_add_f32 v[182:183], v[182:183], v[214:215]
    v_pk_add_f32 v[184:185], v[184:185], v[216:217]
    v_pk_add_f32 v[186:187], v[186:187], v[218:219]
    v_pk_add_f32 v[188:189], v[188:189], v[220:221]
    v_pk_add_f32 v[190:191], v[190:191], v[222:223]
    v_pk_add_f32 v[192:193], v[192:193], v[224:225]
    v_pk_add_f32 v[194:195], v[194:195], v[226:227]
    v_pk_add_f32 v[164:165], v[164:165], v[180:181]
    v_pk_add_f32 v[166:167], v[166:167], v[182:183]
    v_pk_add_f32 v[168:169], v[168:169], v[184:185]
    v_pk_add_f32 v[170:171], v[170:171], v[186:187]
    v_pk_add_f32 v[172:173], v[172:173], v[188:189]
    v_pk_add_f32 v[174:175], v[174:175], v[190:191]
    v_pk_add_f32 v[176:177], v[176:177], v[192:193]
    v_pk_add_f32 v[178:179], v[178:179], v[194:195]
    v_pk_add_f32 v[164:165], v[164:165], v[172:173]
    v_pk_add_f32 v[166:167], v[166:167], v[174:175]
    v_pk_add_f32 v[168:169], v[168:169], v[176:177]
    v_pk_add_f32 v[170:171], v[170:171], v[178:179]
    v_cmp_le_u32 vcc, 2304, v26
    v_cvt_pk_bf16_f32 v164, v164, v164
    v_and_b32 v164, 0xffff0000, v164
    v_cvt_pk_bf16_f32 v165, v165, v165
    v_and_b32 v165, 0xffff0000, v165
    v_cvt_pk_bf16_f32 v166, v166, v166
    v_and_b32 v166, 0xffff0000, v166
    v_cvt_pk_bf16_f32 v167, v167, v167
    v_and_b32 v167, 0xffff0000, v167
    v_cvt_pk_bf16_f32 v168, v168, v168
    v_and_b32 v168, 0xffff0000, v168
    v_cvt_pk_bf16_f32 v169, v169, v169
    v_and_b32 v169, 0xffff0000, v169
    v_cvt_pk_bf16_f32 v170, v170, v170
    v_and_b32 v170, 0xffff0000, v170
    v_cvt_pk_bf16_f32 v171, v171, v171
    v_and_b32 v171, 0xffff0000, v171
    v_cndmask_b32 v172, 0, 1.0, vcc
    v_add_f32 v164, v172, v164
    v_cvt_pk_bf16_f32 v164, v164, v164
    v_and_b32 v164, 0xffff0000, v164
    v_add_f32 v165, v172, v165
    v_cvt_pk_bf16_f32 v165, v165, v165
    v_and_b32 v165, 0xffff0000, v165
    v_add_f32 v166, v172, v166
    v_cvt_pk_bf16_f32 v166, v166, v166
    v_and_b32 v166, 0xffff0000, v166
    v_add_f32 v167, v172, v167
    v_cvt_pk_bf16_f32 v167, v167, v167
    v_and_b32 v167, 0xffff0000, v167
    v_add_f32 v168, 1.0, v168
    v_cvt_pk_bf16_f32 v168, v168, v168
    v_and_b32 v168, 0xffff0000, v168
    v_add_f32 v169, 1.0, v169
    v_cvt_pk_bf16_f32 v169, v169, v169
    v_and_b32 v169, 0xffff0000, v169
    v_add_f32 v170, 1.0, v170
    v_cvt_pk_bf16_f32 v170, v170, v170
    v_and_b32 v170, 0xffff0000, v170
    v_add_f32 v171, 1.0, v171
    v_cvt_pk_bf16_f32 v171, v171, v171
    v_and_b32 v171, 0xffff0000, v171
    ds_write_b128 v26, v[164:167] offset:19456
    s_cmp_lg_u32 s30, 0
    s_cbranch_scc1 k2_q2_19
    ds_write_b128 v27, v[168:171] offset:19456
k2_q2_19:
    s_waitcnt lgkmcnt(0)
    s_barrier
    s_waitcnt vmcnt(18) lgkmcnt(4)
    ds_read_b128 v[128:131], v13 offset:18432
    ds_read_b128 v[132:135], v13 offset:18496
    ds_read_b128 v[136:139], v13 offset:18560
    ds_read_b128 v[140:143], v13 offset:18624
    ds_read_b128 v[144:147], v13 offset:18688
    ds_read_b128 v[148:151], v13 offset:18752
    ds_read_b128 v[152:155], v13 offset:18816
    ds_read_b128 v[156:159], v13 offset:18880
    ds_read_b128 v[160:163], v13 offset:18944
    s_waitcnt vmcnt(9) lgkmcnt(4)
    ds_read_b128 v[164:167], v13 offset:0
    ds_read_b128 v[168:171], v13 offset:64
    ds_read_b128 v[172:175], v13 offset:128
    ds_read_b128 v[176:179], v13 offset:192
    ds_read_b128 v[180:183], v13 offset:256
    ds_read_b128 v[184:187], v13 offset:320
    ds_read_b128 v[188:191], v13 offset:384
    ds_read_b128 v[192:195], v13 offset:448
    ds_read_b128 v[196:199], v13 offset:512
    s_waitcnt vmcnt(0) lgkmcnt(4)
    ds_read_b128 v[200:203], v13 offset:9216
    ds_read_b128 v[204:207], v13 offset:9280
    ds_read_b128 v[208:211], v13 offset:9344
    ds_read_b128 v[212:215], v13 offset:9408
    ds_read_b128 v[216:219], v13 offset:9472
    ds_read_b128 v[220:223], v13 offset:9536
    ds_read_b128 v[224:227], v13 offset:9600
    ds_read_b128 v[228:231], v13 offset:9664
    ds_read_b128 v[232:235], v13 offset:9728
    v_mul_u32_u24 v4, 592, v10
    v_lshl_add_u32 v4, v11, 4, v4
    s_andn2_b32 s52, 9472, s48
    v_add_u32 v4, s52, v4
    v_lshlrev_b32 v5, 4, v11
    v_lshlrev_b32 v7, 31, v12
    v_lshrrev_b32 v6, 1, v11
    v_lshlrev_b32 v6, 8, v6
    v_lshl_add_u32 v6, v10, 4, v6
    v_and_b32 v8, 1, v11
    v_lshl_add_u32 v6, v8, 3, v6
    s_lshr_b32 s52, s28, 1
    s_lshl_b32 s52, s52, 10
    s_and_b32 s53, s28, 1
    s_lshl_b32 s53, s53, 9
    s_add_u32 s52, s52, s53
    s_cmp_lt_u32 s30, 2
    s_cselect_b32 s53, 0, 1048576
    s_add_u32 s53, s53, 1048576
    s_add_u32 s52, s52, s53
    s_lshl_b32 s54, s49, 15
    s_add_u32 s54, s54, s52
    s_waitcnt lgkmcnt(0)
    s_barrier
    ds_read_b128 v[52:55], v5 offset:18944
    ds_read_b128 v[16:19], v4 offset:0
    ds_read_b128 v[20:23], v4 offset:64
    ds_read_b128 v[24:27], v4 offset:128
    ds_read_b128 v[28:31], v4 offset:192
    ds_read_b128 v[32:35], v4 offset:256
    ds_read_b128 v[36:39], v4 offset:320
    ds_read_b128 v[40:43], v4 offset:384
    ds_read_b128 v[44:47], v4 offset:448
    ds_read_b128 v[48:51], v4 offset:512
    s_waitcnt lgkmcnt(9)
    v_xor_b32 v52, v52, v7
    v_and_b32 v52, s48, v52
    v_xor_b32 v53, v53, v7
    v_and_b32 v53, s48, v53
    v_xor_b32 v54, v54, v7
    v_and_b32 v54, s48, v54
    v_xor_b32 v55, v55, v7
    v_and_b32 v55, s48, v55
    s_nop 1
    s_waitcnt lgkmcnt(8)
    v_mfma_f32_16x16x32_bf16 v[236:239], v[16:19], v[56:59], v[52:55]
    v_mfma_f32_16x16x32_bf16 v[240:243], v[16:19], v[92:95], v[52:55]
    v_mfma_f32_16x16x32_bf16 v[244:247], v[16:19], v[128:131], v[52:55]
    v_mfma_f32_16x16x32_bf16 v[248:251], v[16:19], v[164:167], v[52:55]
    v_mfma_f32_16x16x32_bf16 v[252:255], v[16:19], v[200:203], v[52:55]
    s_waitcnt lgkmcnt(7)
    v_mfma_f32_16x16x32_bf16 v[236:239], v[20:23], v[60:63], v[236:239]
    v_mfma_f32_16x16x32_bf16 v[240:243], v[20:23], v[96:99], v[240:243]
    v_mfma_f32_16x16x32_bf16 v[244:247], v[20:23], v[132:135], v[244:247]
    v_mfma_f32_16x16x32_bf16 v[248:251], v[20:23], v[168:171], v[248:251]
    v_mfma_f32_16x16x32_bf16 v[252:255], v[20:23], v[204:207], v[252:255]
    s_waitcnt lgkmcnt(6)
    v_mfma_f32_16x16x32_bf16 v[236:239], v[24:27], v[64:67], v[236:239]
    v_mfma_f32_16x16x32_bf16 v[240:243], v[24:27], v[100:103], v[240:243]
    v_mfma_f32_16x16x32_bf16 v[244:247], v[24:27], v[136:139], v[244:247]
    v_mfma_f32_16x16x32_bf16 v[248:251], v[24:27], v[172:175], v[248:251]
    v_mfma_f32_16x16x32_bf16 v[252:255], v[24:27], v[208:211], v[252:255]
    s_waitcnt lgkmcnt(5)
    v_mfma_f32_16x16x32_bf16 v[236:239], v[28:31], v[68:71], v[236:239]
    v_mfma_f32_16x16x32_bf16 v[240:243], v[28:31], v[104:107], v[240:243]
    v_mfma_f32_16x16x32_bf16 v[244:247], v[28:31], v[140:143], v[244:247]
    v_mfma_f32_16x16x32_bf16 v[248:251], v[28:31], v[176:179], v[248:251]
    v_mfma_f32_16x16x32_bf16 v[252:255], v[28:31], v[212:215], v[252:255]
    s_waitcnt lgkmcnt(4)
    v_mfma_f32_16x16x32_bf16 v[236:239], v[32:35], v[72:75], v[236:239]
    v_mfma_f32_16x16x32_bf16 v[240:243], v[32:35], v[108:111], v[240:243]
    v_mfma_f32_16x16x32_bf16 v[244:247], v[32:35], v[144:147], v[244:247]
    v_mfma_f32_16x16x32_bf16 v[248:251], v[32:35], v[180:183], v[248:251]
    v_mfma_f32_16x16x32_bf16 v[252:255], v[32:35], v[216:219], v[252:255]
    s_waitcnt lgkmcnt(3)
    v_mfma_f32_16x16x32_bf16 v[236:239], v[36:39], v[76:79], v[236:239]
    v_mfma_f32_16x16x32_bf16 v[240:243], v[36:39], v[112:115], v[240:243]
    v_mfma_f32_16x16x32_bf16 v[244:247], v[36:39], v[148:151], v[244:247]
    v_mfma_f32_16x16x32_bf16 v[248:251], v[36:39], v[184:187], v[248:251]
    v_mfma_f32_16x16x32_bf16 v[252:255], v[36:39], v[220:223], v[252:255]
    s_waitcnt lgkmcnt(2)
    v_mfma_f32_16x16x32_bf16 v[236:239], v[40:43], v[80:83], v[236:239]
    v_mfma_f32_16x16x32_bf16 v[240:243], v[40:43], v[116:119], v[240:243]
    v_mfma_f32_16x16x32_bf16 v[244:247], v[40:43], v[152:155], v[244:247]
    v_mfma_f32_16x16x32_bf16 v[248:251], v[40:43], v[188:191], v[248:251]
    v_mfma_f32_16x16x32_bf16 v[252:255], v[40:43], v[224:227], v[252:255]
    s_waitcnt lgkmcnt(1)
    v_mfma_f32_16x16x32_bf16 v[236:239], v[44:47], v[84:87], v[236:239]
    v_mfma_f32_16x16x32_bf16 v[240:243], v[44:47], v[120:123], v[240:243]
    v_mfma_f32_16x16x32_bf16 v[244:247], v[44:47], v[156:159], v[244:247]
    v_mfma_f32_16x16x32_bf16 v[248:251], v[44:47], v[192:195], v[248:251]
    v_mfma_f32_16x16x32_bf16 v[252:255], v[44:47], v[228:231], v[252:255]
    s_waitcnt lgkmcnt(0)
    v_mfma_f32_16x16x32_bf16 v[236:239], v[48:51], v[88:91], v[236:239]
    v_mfma_f32_16x16x32_bf16 v[240:243], v[48:51], v[124:127], v[240:243]
    v_mfma_f32_16x16x32_bf16 v[244:247], v[48:51], v[160:163], v[244:247]
    v_mfma_f32_16x16x32_bf16 v[248:251], v[48:51], v[196:199], v[248:251]
    v_mfma_f32_16x16x32_bf16 v[252:255], v[48:51], v[232:235], v[252:255]
    s_nop 7
    s_cmp_eq_u32 s28, 64
    s_cbranch_scc1 k2_ny_20
    v_cvt_pk_bf16_f32 v236, v236, v237
    v_cvt_pk_bf16_f32 v237, v238, v239
    buffer_store_dwordx2 v[236:237], v6, s[16:19], s54 offen
    s_add_u32 s54, s54, 32768
    v_cvt_pk_bf16_f32 v240, v240, v241
    v_cvt_pk_bf16_f32 v241, v242, v243
    buffer_store_dwordx2 v[240:241], v6, s[16:19], s54 offen
    s_add_u32 s54, s54, 32768
    v_cvt_pk_bf16_f32 v244, v244, v245
    v_cvt_pk_bf16_f32 v245, v246, v247
    buffer_store_dwordx2 v[244:245], v6, s[16:19], s54 offen
    s_add_u32 s54, s54, 32768
    v_cvt_pk_bf16_f32 v248, v248, v249
    v_cvt_pk_bf16_f32 v249, v250, v251
    buffer_store_dwordx2 v[248:249], v6, s[16:19], s54 offen
    s_add_u32 s54, s54, 32768
    v_cvt_pk_bf16_f32 v252, v252, v253
    v_cvt_pk_bf16_f32 v253, v254, v255
    buffer_store_dwordx2 v[252:253], v6, s[16:19], s54 offen
    s_add_u32 s54, s54, 32768
    s_endpgm
k2_ny_20:
    s_cmp_ge_u32 s30, 2
    s_cbranch_scc1 k2_end_16
    v_lshlrev_b32 v6, 2, v12
    s_lshl_b32 s54, s49, 6
    s_mov_b64 exec, 0xffff
    s_add_u32 s54, s54, 16384
    buffer_store_dword v236, v6, s[16:19], s54 offen offset:0
    buffer_store_dword v240, v6, s[16:19], s54 offen offset:64
    buffer_store_dword v244, v6, s[16:19], s54 offen offset:128
    buffer_store_dword v248, v6, s[16:19], s54 offen offset:192
    buffer_store_dword v252, v6, s[16:19], s54 offen offset:256
    s_endpgm
k2_pf_15:
    s_cmp_ge_u32 s2, 166
    s_cbranch_scc1 k2_w1_21
    s_sub_u32 s29, s2, 112
    s_lshl_b32 s64, s29, 7
    s_mov_b32 s30, 0
    v_and_b32 v1, 7, v0
    v_lshrrev_b32 v2, 3, v0
    v_add_u32 v4, s30, v2
    v_mul_u32_u24 v3, 6912, v4
    v_lshl_add_u32 v3, v1, 4, v3
    v_lshlrev_b32 v4, 1, v4
    s_waitcnt lgkmcnt(0)
    buffer_load_dwordx4 v[32:35], v3, s[56:59], s64 offen
    s_add_u32 s64, s64, 442368
    buffer_load_dwordx4 v[36:39], v3, s[56:59], s64 offen
    s_add_u32 s64, s64, 442368
    buffer_load_dwordx4 v[40:43], v3, s[56:59], s64 offen
    s_add_u32 s64, s64, 442368
    buffer_load_dwordx4 v[44:47], v3, s[56:59], s64 offen
    s_add_u32 s64, s64, 442368
    buffer_load_dwordx4 v[48:51], v3, s[56:59], s64 offen
    s_add_u32 s64, s64, 442368
    buffer_load_dwordx4 v[52:55], v3, s[56:59], s64 offen
    s_add_u32 s64, s64, 442368
    buffer_load_dwordx4 v[56:59], v3, s[56:59], s64 offen
    s_add_u32 s64, s64, 442368
    buffer_load_dwordx4 v[60:63], v3, s[56:59], s64 offen
    s_add_u32 s64, s64, 442368
    buffer_load_dwordx4 v[64:67], v3, s[56:59], s64 offen
    buffer_load_ushort v8, v4, s[60:63], 0 offen offset:0
    buffer_load_ushort v9, v4, s[60:63], 0 offen offset:128
    buffer_load_ushort v10, v4, s[60:63], 0 offen offset:256
    buffer_load_ushort v11, v4, s[60:63], 0 offen offset:384
    buffer_load_ushort v12, v4, s[60:63], 0 offen offset:512
    buffer_load_ushort v13, v4, s[60:63], 0 offen offset:640
    buffer_load_ushort v14, v4, s[60:63], 0 offen offset:768
    buffer_load_ushort v15, v4, s[60:63], 0 offen offset:896
    buffer_load_ushort v16, v4, s[60:63], 0 offen offset:1024
    v_mov_b32 v112, 0
    v_mov_b32 v113, 0
    v_mov_b32 v114, 0
    v_mov_b32 v115, 0
    v_mov_b32 v116, 0
    v_mov_b32 v117, 0
    v_mov_b32 v118, 0
    v_mov_b32 v119, 0
    s_mov_b32 s25, 0x3fb8aa3b
    s_waitcnt vmcnt(0)
    v_lshlrev_b32 v8, 16, v8
    v_mul_f32 v120, s25, v8
    v_exp_f32 v120, -v120
    s_nop 0
    v_add_f32 v120, 1.0, v120
    v_rcp_f32 v120, v120
    s_nop 0
    v_mul_f32 v8, v8, v120
    v_cvt_pk_bf16_f32 v8, v8, v8
    v_and_b32 v8, 0xffff0000, v8
    v_lshlrev_b32 v9, 16, v9
    v_mul_f32 v120, s25, v9
    v_exp_f32 v120, -v120
    s_nop 0
    v_add_f32 v120, 1.0, v120
    v_rcp_f32 v120, v120
    s_nop 0
    v_mul_f32 v9, v9, v120
    v_cvt_pk_bf16_f32 v9, v9, v9
    v_and_b32 v9, 0xffff0000, v9
    v_lshlrev_b32 v10, 16, v10
    v_mul_f32 v120, s25, v10
    v_exp_f32 v120, -v120
    s_nop 0
    v_add_f32 v120, 1.0, v120
    v_rcp_f32 v120, v120
    s_nop 0
    v_mul_f32 v10, v10, v120
    v_cvt_pk_bf16_f32 v10, v10, v10
    v_and_b32 v10, 0xffff0000, v10
    v_lshlrev_b32 v11, 16, v11
    v_mul_f32 v120, s25, v11
    v_exp_f32 v120, -v120
    s_nop 0
    v_add_f32 v120, 1.0, v120
    v_rcp_f32 v120, v120
    s_nop 0
    v_mul_f32 v11, v11, v120
    v_cvt_pk_bf16_f32 v11, v11, v11
    v_and_b32 v11, 0xffff0000, v11
    v_lshlrev_b32 v12, 16, v12
    v_mul_f32 v120, s25, v12
    v_exp_f32 v120, -v120
    s_nop 0
    v_add_f32 v120, 1.0, v120
    v_rcp_f32 v120, v120
    s_nop 0
    v_mul_f32 v12, v12, v120
    v_cvt_pk_bf16_f32 v12, v12, v12
    v_and_b32 v12, 0xffff0000, v12
    v_lshlrev_b32 v13, 16, v13
    v_mul_f32 v120, s25, v13
    v_exp_f32 v120, -v120
    s_nop 0
    v_add_f32 v120, 1.0, v120
    v_rcp_f32 v120, v120
    s_nop 0
    v_mul_f32 v13, v13, v120
    v_cvt_pk_bf16_f32 v13, v13, v13
    v_and_b32 v13, 0xffff0000, v13
    v_lshlrev_b32 v14, 16, v14
    v_mul_f32 v120, s25, v14
    v_exp_f32 v120, -v120
    s_nop 0
    v_add_f32 v120, 1.0, v120
    v_rcp_f32 v120, v120
    s_nop 0
    v_mul_f32 v14, v14, v120
    v_cvt_pk_bf16_f32 v14, v14, v14
    v_and_b32 v14, 0xffff0000, v14
    v_lshlrev_b32 v15, 16, v15
    v_mul_f32 v120, s25, v15
    v_exp_f32 v120, -v120
    s_nop 0
    v_add_f32 v120, 1.0, v120
    v_rcp_f32 v120, v120
    s_nop 0
    v_mul_f32 v15, v15, v120
    v_cvt_pk_bf16_f32 v15, v15, v15
    v_and_b32 v15, 0xffff0000, v15
    v_lshlrev_b32 v16, 16, v16
    v_mul_f32 v120, s25, v16
    v_exp_f32 v120, -v120
    s_nop 0
    v_add_f32 v120, 1.0, v120
    v_rcp_f32 v120, v120
    s_nop 0
    v_mul_f32 v16, v16, v120
    v_cvt_pk_bf16_f32 v16, v16, v16
    v_and_b32 v16, 0xffff0000, v16
    v_lshlrev_b32 v120, 16, v32
    v_and_b32 v121, 0xffff0000, v32
    v_fmac_f32 v112, v120, v8
    v_fmac_f32 v113, v121, v8
    v_lshlrev_b32 v120, 16, v33
    v_and_b32 v121, 0xffff0000, v33
    v_fmac_f32 v114, v120, v8
    v_fmac_f32 v115, v121, v8
    v_lshlrev_b32 v120, 16, v34
    v_and_b32 v121, 0xffff0000, v34
    v_fmac_f32 v116, v120, v8
    v_fmac_f32 v117, v121, v8
    v_lshlrev_b32 v120, 16, v35
    v_and_b32 v121, 0xffff0000, v35
    v_fmac_f32 v118, v120, v8
    v_fmac_f32 v119, v121, v8
    v_lshlrev_b32 v120, 16, v36
    v_and_b32 v121, 0xffff0000, v36
    v_fmac_f32 v112, v120, v9
    v_fmac_f32 v113, v121, v9
    v_lshlrev_b32 v120, 16, v37
    v_and_b32 v121, 0xffff0000, v37
    v_fmac_f32 v114, v120, v9
    v_fmac_f32 v115, v121, v9
    v_lshlrev_b32 v120, 16, v38
    v_and_b32 v121, 0xffff0000, v38
    v_fmac_f32 v116, v120, v9
    v_fmac_f32 v117, v121, v9
    v_lshlrev_b32 v120, 16, v39
    v_and_b32 v121, 0xffff0000, v39
    v_fmac_f32 v118, v120, v9
    v_fmac_f32 v119, v121, v9
    v_lshlrev_b32 v120, 16, v40
    v_and_b32 v121, 0xffff0000, v40
    v_fmac_f32 v112, v120, v10
    v_fmac_f32 v113, v121, v10
    v_lshlrev_b32 v120, 16, v41
    v_and_b32 v121, 0xffff0000, v41
    v_fmac_f32 v114, v120, v10
    v_fmac_f32 v115, v121, v10
    v_lshlrev_b32 v120, 16, v42
    v_and_b32 v121, 0xffff0000, v42
    v_fmac_f32 v116, v120, v10
    v_fmac_f32 v117, v121, v10
    v_lshlrev_b32 v120, 16, v43
    v_and_b32 v121, 0xffff0000, v43
    v_fmac_f32 v118, v120, v10
    v_fmac_f32 v119, v121, v10
    v_lshlrev_b32 v120, 16, v44
    v_and_b32 v121, 0xffff0000, v44
    v_fmac_f32 v112, v120, v11
    v_fmac_f32 v113, v121, v11
    v_lshlrev_b32 v120, 16, v45
    v_and_b32 v121, 0xffff0000, v45
    v_fmac_f32 v114, v120, v11
    v_fmac_f32 v115, v121, v11
    v_lshlrev_b32 v120, 16, v46
    v_and_b32 v121, 0xffff0000, v46
    v_fmac_f32 v116, v120, v11
    v_fmac_f32 v117, v121, v11
    v_lshlrev_b32 v120, 16, v47
    v_and_b32 v121, 0xffff0000, v47
    v_fmac_f32 v118, v120, v11
    v_fmac_f32 v119, v121, v11
    v_lshlrev_b32 v120, 16, v48
    v_and_b32 v121, 0xffff0000, v48
    v_fmac_f32 v112, v120, v12
    v_fmac_f32 v113, v121, v12
    v_lshlrev_b32 v120, 16, v49
    v_and_b32 v121, 0xffff0000, v49
    v_fmac_f32 v114, v120, v12
    v_fmac_f32 v115, v121, v12
    v_lshlrev_b32 v120, 16, v50
    v_and_b32 v121, 0xffff0000, v50
    v_fmac_f32 v116, v120, v12
    v_fmac_f32 v117, v121, v12
    v_lshlrev_b32 v120, 16, v51
    v_and_b32 v121, 0xffff0000, v51
    v_fmac_f32 v118, v120, v12
    v_fmac_f32 v119, v121, v12
    v_lshlrev_b32 v120, 16, v52
    v_and_b32 v121, 0xffff0000, v52
    v_fmac_f32 v112, v120, v13
    v_fmac_f32 v113, v121, v13
    v_lshlrev_b32 v120, 16, v53
    v_and_b32 v121, 0xffff0000, v53
    v_fmac_f32 v114, v120, v13
    v_fmac_f32 v115, v121, v13
    v_lshlrev_b32 v120, 16, v54
    v_and_b32 v121, 0xffff0000, v54
    v_fmac_f32 v116, v120, v13
    v_fmac_f32 v117, v121, v13
    v_lshlrev_b32 v120, 16, v55
    v_and_b32 v121, 0xffff0000, v55
    v_fmac_f32 v118, v120, v13
    v_fmac_f32 v119, v121, v13
    v_lshlrev_b32 v120, 16, v56
    v_and_b32 v121, 0xffff0000, v56
    v_fmac_f32 v112, v120, v14
    v_fmac_f32 v113, v121, v14
    v_lshlrev_b32 v120, 16, v57
    v_and_b32 v121, 0xffff0000, v57
    v_fmac_f32 v114, v120, v14
    v_fmac_f32 v115, v121, v14
    v_lshlrev_b32 v120, 16, v58
    v_and_b32 v121, 0xffff0000, v58
    v_fmac_f32 v116, v120, v14
    v_fmac_f32 v117, v121, v14
    v_lshlrev_b32 v120, 16, v59
    v_and_b32 v121, 0xffff0000, v59
    v_fmac_f32 v118, v120, v14
    v_fmac_f32 v119, v121, v14
    v_lshlrev_b32 v120, 16, v60
    v_and_b32 v121, 0xffff0000, v60
    v_fmac_f32 v112, v120, v15
    v_fmac_f32 v113, v121, v15
    v_lshlrev_b32 v120, 16, v61
    v_and_b32 v121, 0xffff0000, v61
    v_fmac_f32 v114, v120, v15
    v_fmac_f32 v115, v121, v15
    v_lshlrev_b32 v120, 16, v62
    v_and_b32 v121, 0xffff0000, v62
    v_fmac_f32 v116, v120, v15
    v_fmac_f32 v117, v121, v15
    v_lshlrev_b32 v120, 16, v63
    v_and_b32 v121, 0xffff0000, v63
    v_fmac_f32 v118, v120, v15
    v_fmac_f32 v119, v121, v15
    v_lshlrev_b32 v120, 16, v64
    v_and_b32 v121, 0xffff0000, v64
    v_fmac_f32 v112, v120, v16
    v_fmac_f32 v113, v121, v16
    v_lshlrev_b32 v120, 16, v65
    v_and_b32 v121, 0xffff0000, v65
    v_fmac_f32 v114, v120, v16
    v_fmac_f32 v115, v121, v16
    v_lshlrev_b32 v120, 16, v66
    v_and_b32 v121, 0xffff0000, v66
    v_fmac_f32 v116, v120, v16
    v_fmac_f32 v117, v121, v16
    v_lshlrev_b32 v120, 16, v67
    v_and_b32 v121, 0xffff0000, v67
    v_fmac_f32 v118, v120, v16
    v_fmac_f32 v119, v121, v16
    s_nop 1
    v_add_f32_dpp v112, v112, v112 row_ror:8 row_mask:0xf bank_mask:0xf
    v_add_f32_dpp v113, v113, v113 row_ror:8 row_mask:0xf bank_mask:0xf
    v_add_f32_dpp v114, v114, v114 row_ror:8 row_mask:0xf bank_mask:0xf
    v_add_f32_dpp v115, v115, v115 row_ror:8 row_mask:0xf bank_mask:0xf
    v_add_f32_dpp v116, v116, v116 row_ror:8 row_mask:0xf bank_mask:0xf
    v_add_f32_dpp v117, v117, v117 row_ror:8 row_mask:0xf bank_mask:0xf
    v_add_f32_dpp v118, v118, v118 row_ror:8 row_mask:0xf bank_mask:0xf
    v_add_f32_dpp v119, v119, v119 row_ror:8 row_mask:0xf bank_mask:0xf
    v_mov_b32 v96, v112
    v_mov_b32 v97, v113
    v_mov_b32 v98, v114
    v_mov_b32 v99, v115
    v_mov_b32 v100, v116
    v_mov_b32 v101, v117
    v_mov_b32 v102, v118
    v_mov_b32 v103, v119
    s_nop 1
    v_permlane16_swap_b32 v96, v112
    v_permlane16_swap_b32 v97, v113
    v_permlane16_swap_b32 v98, v114
    v_permlane16_swap_b32 v99, v115
    v_permlane16_swap_b32 v100, v116
    v_permlane16_swap_b32 v101, v117
    v_permlane16_swap_b32 v102, v118
    v_permlane16_swap_b32 v103, v119
    s_nop 1
    v_add_f32 v112, v112, v96
    v_add_f32 v113, v113, v97
    v_add_f32 v114, v114, v98
    v_add_f32 v115, v115, v99
    v_add_f32 v116, v116, v100
    v_add_f32 v117, v117, v101
    v_add_f32 v118, v118, v102
    v_add_f32 v119, v119, v103
    v_mov_b32 v96, v112
    v_mov_b32 v97, v113
    v_mov_b32 v98, v114
    v_mov_b32 v99, v115
    v_mov_b32 v100, v116
    v_mov_b32 v101, v117
    v_mov_b32 v102, v118
    v_mov_b32 v103, v119
    s_nop 1
    v_permlane32_swap_b32 v96, v112
    v_permlane32_swap_b32 v97, v113
    v_permlane32_swap_b32 v98, v114
    v_permlane32_swap_b32 v99, v115
    v_permlane32_swap_b32 v100, v116
    v_permlane32_swap_b32 v101, v117
    v_permlane32_swap_b32 v102, v118
    v_permlane32_swap_b32 v103, v119
    s_nop 1
    v_add_f32 v112, v112, v96
    v_add_f32 v113, v113, v97
    v_add_f32 v114, v114, v98
    v_add_f32 v115, v115, v99
    v_add_f32 v116, v116, v100
    v_add_f32 v117, v117, v101
    v_add_f32 v118, v118, v102
    v_add_f32 v119, v119, v103
    v_lshrrev_b32 v120, 6, v0
    v_lshlrev_b32 v120, 8, v120
    v_lshl_add_u32 v120, v1, 5, v120
    s_mov_b64 exec, 0xff
    ds_write_b128 v120, v[112:115]
    ds_write_b128 v120, v[116:119] offset:16
    s_mov_b64 exec, -1
    s_waitcnt lgkmcnt(0)
    s_barrier
    v_cmp_gt_u32 vcc, 64, v0
    s_and_saveexec_b64 s[26:27], vcc
    s_cbranch_execz k2_end_16
    v_lshlrev_b32 v120, 2, v0
    ds_read_b32 v32, v120 offset:0
    ds_read_b32 v33, v120 offset:256
    ds_read_b32 v34, v120 offset:512
    ds_read_b32 v35, v120 offset:768
    ds_read_b32 v36, v120 offset:1024
    ds_read_b32 v37, v120 offset:1280
    ds_read_b32 v38, v120 offset:1536
    ds_read_b32 v39, v120 offset:1792
    s_mul_i32 s28, s29, 7282
    s_lshr_b32 s28, s28, 16
    s_mul_i32 s31, s28, 9
    s_sub_u32 s31, s29, s31
    s_lshl_b32 s31, s31, 6
    v_add_u32 v3, s31, v0
    s_cmp_eq_u32 s28, 5
    v_sub_u32 v4, 864, v3
    v_cmp_lt_u32 vcc, 288, v3
    s_cselect_b64 vcc, 0, vcc
    s_nop 1
    v_cndmask_b32 v3, v3, v4, vcc
    s_mul_i32 s31, s28, 576
    v_add_u32 v3, s31, v3
    v_lshlrev_b32 v3, 2, v3
    s_cmp_eq_u32 s28, 4
    s_cselect_b32 s31, 1.0, 0
    s_waitcnt lgkmcnt(0)
    v_add_f32 v32, v32, v36
    v_add_f32 v33, v33, v37
    v_add_f32 v34, v34, v38
    v_add_f32 v35, v35, v39
    v_add_f32 v32, v32, v34
    v_add_f32 v33, v33, v35
    v_add_f32 v32, v32, v33
    v_cvt_pk_bf16_f32 v32, v32, v32
    v_and_b32 v32, 0xffff0000, v32
    v_add_f32 v32, s31, v32
    v_cvt_pk_bf16_f32 v32, v32, v32
    v_and_b32 v32, 0xffff0000, v32
    buffer_store_dword v32, v3, s[16:19], 0 offen offset:0
    s_endpgm
k2_w1_21:
    s_cmp_ge_u32 s2, 168
    s_cbranch_scc1 k2_z_22
    v_min_u32 v1, 287, v0
    v_lshlrev_b32 v1, 7, v1
    v_mov_b32 v4, 0
    v_mov_b32 v5, 0
    v_mov_b32 v6, 0
    v_mov_b32 v7, 0
    s_mov_b32 s31, 0x50000
    s_waitcnt lgkmcnt(0)
    buffer_store_dwordx4 v[4:7], v1, s[16:19], s31 offen
    buffer_store_dwordx4 v[4:7], v1, s[16:19], s31 offen offset:16
    s_branch k2_end_16
k2_z_22:
    s_and_b32 s31, s2, 7
    s_sub_u32 s32, s2, 168
    s_lshr_b32 s32, s32, 3
    v_mul_u32_u24 v1, 11, v0
    v_add_u32 v1, s32, v1
    v_mov_b32 v6, 0x40000000
    v_lshrrev_b32 v8, 1, v1
    v_lshrrev_b32 v2, 4, v8
    v_and_b32 v3, 15, v8
    s_lshr_b32 s34, s31, 1
    s_lshl_b32 s34, s34, 7
    v_add_u32 v7, s34, v2
    v_add_u32 v9, 384, v2
    v_cmp_gt_u32 vcc, 128, v2
    s_nop 1
    v_cndmask_b32 v7, v9, v7, vcc
    v_lshlrev_b32 v7, 12, v7
    v_lshl_add_u32 v7, v3, 7, v7
    v_cmp_gt_u32 vcc, 129, v2
    s_nop 1
    v_cndmask_b32 v7, v6, v7, vcc
    v_and_b32 v3, 1, v1
    v_cmp_eq_u32 vcc, 0, v3
    s_nop 1
    v_cndmask_b32 v9, v6, v7, vcc
    v_cndmask_b32 v7, v7, v6, vcc
    v_lshlrev_b32 v5, 7, v1
    v_cmp_gt_u32 vcc, 288, v1
    s_mov_b32 s37, 32768
    s_nop 0
    v_cndmask_b32 v5, v6, v5, vcc
    s_waitcnt lgkmcnt(0)
    buffer_load_dword v15, v5, s[16:19], s37 offen
    buffer_load_dword v12, v9, s[68:71], 0 offen
    buffer_load_dword v13, v7, s[72:75], 0 offen
    v_add_u32 v1, 1152, v1
    s_mul_i32 s35, s31, 1152
    s_mov_b32 s36, 477218589
    v_mul_hi_u32 v2, v1, s36
    v_mul_u32_u24 v3, 9, v2
    v_sub_u32 v3, v1, v3
    v_mul_u32_u24 v4, 9216, v2
    v_lshl_add_u32 v4, v3, 7, v4
    v_cmp_gt_u32 vcc, 576, v2
    s_nop 1
    v_cndmask_b32 v4, v6, v4, vcc
    buffer_load_dword v14, v4, s[24:27], s35 offen
    s_waitcnt vmcnt(0)
k2_end_16:
    s_endpgm
.globl k3_seq_kernel
.p2align 8
.type k3_seq_kernel,@function
k3_seq_kernel:
    s_load_dwordx2 s[8:9], s[0:1], 0
    s_load_dwordx2 s[12:13], s[0:1], 8
    s_load_dwordx2 s[16:17], s[0:1], 96
    s_load_dwordx2 s[20:21], s[0:1], 16
    s_load_dwordx2 s[24:25], s[0:1], 56
    s_mov_b32 s10, 2359296
    s_mov_b32 s11, 0x00020000
    s_mov_b32 s14, 8388608
    s_mov_b32 s15, 0x00020000
    s_mov_b32 s18, 268435456
    s_mov_b32 s19, 0x00020000
    s_mov_b32 s22, 8388608
    s_mov_b32 s23, 0x00020000
    s_mov_b32 s26, 5308416
    s_mov_b32 s27, 0x00020000
    s_cmp_ge_u32 s2, 256
    s_cbranch_scc1 k3_end_23
    s_cmp_ge_u32 s2, 192
    s_cbranch_scc1 k3_pf_24
    s_lshr_b32 s31, s2, 3
    s_mul_i32 s32, s31, 21846
    s_lshr_b32 s32, s32, 16
    s_mul_i32 s33, s32, 3
    s_sub_u32 s33, s31, s33
    s_and_b32 s34, s2, 1
    s_mul_i32 s34, s34, 3
    s_add_u32 s28, s33, s34
    s_bfe_u32 s34, s2, 0x20001
    s_lshl_b32 s34, s34, 3
    s_add_u32 s29, s32, s34
    v_and_b32 v1, 63, v0
    v_lshrrev_b32 v2, 6, v0
    v_lshlrev_b32 v4, 4, v1
    v_readfirstlane_b32 s30, v2
    s_lshl_b32 s35, s30, 1
    v_xor_b32 v6, s35, v1
    v_lshlrev_b32 v6, 4, v6
    v_xor_b32 v7, 16, v6
    v_add_u32 v7, 2048, v7
    s_lshl_b32 s36, s29, 4
    s_add_u32 s36, s36, s35
    s_lshl_b32 s36, s36, 12
    s_lshl_b32 s37, s30, 12
    s_mov_b32 m0, s37
    s_waitcnt lgkmcnt(0)
    buffer_load_dwordx4 v6, s[12:15], s36 offen lds
    buffer_load_dwordx4 v6, s[12:15], s36 offen offset:1024 lds
    buffer_load_dwordx4 v7, s[12:15], s36 offen offset:2048 lds
    buffer_load_dwordx4 v7, s[12:15], s36 offen offset:3072 lds
    s_add_u32 m0, s37, 32768
    s_nop 0
    buffer_load_dwordx4 v6, s[20:23], s36 offen lds
    buffer_load_dwordx4 v6, s[20:23], s36 offen offset:1024 lds
    buffer_load_dwordx4 v7, s[20:23], s36 offen offset:2048 lds
    buffer_load_dwordx4 v7, s[20:23], s36 offen offset:3072 lds
    s_barrier
    s_cmp_lt_u32 s30, 3
    s_cselect_b32 s39, 0, 950272
    s_mov_b32 s41, 0x00008000
    s_cselect_b32 s41, 0x80000000, s41
    s_cselect_b32 s42, 0, 32768
    s_mul_i32 s43, s28, 3
    s_add_u32 s43, s43, s30
    s_lshl_b32 s43, s43, 15
    s_add_u32 s39, s39, s43
    s_add_u32 s39, s39, 1048576
    s_cmp_eq_u32 s30, 6
    s_cselect_b32 s39, 1638400, s39
    s_cselect_b32 s41, 0x80000000, s41
    s_cselect_b32 s42, 0, s42
    s_cmp_eq_u32 s28, 0
    s_cselect_b32 s40, 7, 6
    v_and_b32 v2, 15, v1
    v_cmp_ne_u32 vcc, 0, v2
    s_cmp_eq_u32 s30, 6
    s_cselect_b64 vcc, vcc, 0
    v_mov_b32 v2, 0x40000000
    s_nop 0
    v_cndmask_b32 v5, v4, v2, vcc
    s_cmp_ge_u32 s30, s40
    s_cbranch_scc1 k3_na_26
    buffer_load_dwordx4 v[104:107], v5, s[16:19], s39 offen offset:0
    buffer_load_dwordx4 v[108:111], v5, s[16:19], s39 offen offset:1024
    buffer_load_dwordx4 v[112:115], v5, s[16:19], s39 offen offset:2048
    buffer_load_dwordx4 v[116:119], v5, s[16:19], s39 offen offset:3072
    s_add_u32 s39, s39, 4096
    buffer_load_dwordx4 v[120:123], v5, s[16:19], s39 offen offset:0
    buffer_load_dwordx4 v[124:127], v5, s[16:19], s39 offen offset:1024
    buffer_load_dwordx4 v[128:131], v5, s[16:19], s39 offen offset:2048
    buffer_load_dwordx4 v[132:135], v5, s[16:19], s39 offen offset:3072
    s_add_u32 s39, s39, 4096
k3_na_26:
    s_cmp_lg_u32 s30, 7
    s_cbranch_scc1 k3_nt_27
    s_cmp_lg_u32 s29, 0
    s_cbranch_scc1 k3_n5_28
    s_mov_b32 s38, 2097152
    s_mov_b32 m0, 65536
    s_nop 0
    buffer_load_dwordx4 v4, s[12:15], s38 offen lds
    buffer_load_dwordx4 v4, s[12:15], s38 offen offset:1024 lds
    s_mov_b32 m0, 67584
    s_nop 0
    buffer_load_dwordx4 v4, s[20:23], s38 offen lds
    buffer_load_dwordx4 v4, s[20:23], s38 offen offset:1024 lds
k3_n5_28:
    s_waitcnt vmcnt(0)
    s_barrier
    s_mul_i32 s45, s28, 192
    v_lshrrev_b32 v2, 4, v1
    v_and_b32 v3, 15, v1
    v_lshlrev_b32 v3, 4, v3
    v_add_u32 v3, s45, v3
    v_add_u32 v72, 4608, v3
    v_add_u32 v73, 5760, v3
    v_cmp_eq_u32 vcc, 1, v2
    s_nop 1
    v_cndmask_b32 v72, v72, v73, vcc
    v_add_u32 v73, 16384, v3
    v_cmp_eq_u32 vcc, 2, v2
    s_nop 1
    v_cndmask_b32 v72, v72, v73, vcc
    v_mov_b32 v73, 17536
    v_cmp_eq_u32 vcc, 3, v2
    s_nop 1
    v_cndmask_b32 v72, v72, v73, vcc
    s_mov_b32 m0, 86016
    s_nop 0
    buffer_load_dwordx4 v72, s[16:19], 0 offen lds
    s_lshr_b32 s45, s45, 1
    s_sub_u32 s46, 1056, s45
    v_and_b32 v73, 7, v1
    v_lshlrev_b32 v73, 4, v73
    v_add_u32 v74, s45, v73
    v_add_u32 v3, s46, v73
    v_and_b32 v72, 15, v1
    v_cmp_gt_u32 vcc, 8, v72
    v_mov_b32 v73, 576
    s_nop 0
    v_cndmask_b32 v74, v3, v74, vcc
    v_cmp_eq_u32 vcc, 15, v72
    s_nop 1
    v_cndmask_b32 v73, v74, v73, vcc
    s_lshl_b32 s47, s29, 4
    v_add_u32 v2, s47, v2
    v_cmp_eq_u32 s[48:49], 0, v2
    v_mul_u32_u24 v2, 1152, v2
    v_add_u32 v72, v73, v2
    v_sub_u32 v74, v73, v2
    v_add_u32 v74, 1165824, v74
    s_mov_b32 m0, 69632
    s_mov_b32 s46, 0
    buffer_load_dwordx4 v72, s[8:11], s46 offen lds
    s_mov_b32 m0, 70656
    s_mov_b32 s46, 4608
    buffer_load_dwordx4 v72, s[8:11], s46 offen lds
    s_mov_b32 m0, 71680
    s_mov_b32 s46, 9216
    buffer_load_dwordx4 v72, s[8:11], s46 offen lds
    s_mov_b32 m0, 72704
    s_mov_b32 s46, 13824
    buffer_load_dwordx4 v72, s[8:11], s46 offen lds
    s_mov_b32 m0, 73728
    s_mov_b32 s46, 13824
    buffer_load_dwordx4 v74, s[8:11], s46 offen lds
    s_mov_b32 m0, 74752
    s_mov_b32 s46, 9216
    buffer_load_dwordx4 v74, s[8:11], s46 offen lds
    s_mov_b32 m0, 75776
    s_mov_b32 s46, 4608
    buffer_load_dwordx4 v74, s[8:11], s46 offen lds
    s_mov_b32 m0, 76800
    s_mov_b32 s46, 0
    buffer_load_dwordx4 v74, s[8:11], s46 offen lds
    s_mov_b32 m0, 77824
    v_add_u32 v3, 1193472, v74
    v_add_u32 v2, 589824, v73
    v_cndmask_b32 v3, v3, v2, s[48:49]
    buffer_load_dwordx4 v3, s[8:11], 0 offen lds
    s_mov_b32 m0, 78848
    s_mov_b32 s46, 1188864
    buffer_load_dwordx4 v74, s[8:11], s46 offen lds
    s_mov_b32 m0, 79872
    s_mov_b32 s46, 1184256
    buffer_load_dwordx4 v74, s[8:11], s46 offen lds
    s_mov_b32 m0, 80896
    s_mov_b32 s46, 1179648
    buffer_load_dwordx4 v74, s[8:11], s46 offen lds
    s_mov_b32 m0, 81920
    v_add_u32 v3, 1179648, v72
    v_add_u32 v2, 1769472, v73
    v_cndmask_b32 v3, v3, v2, s[48:49]
    buffer_load_dwordx4 v3, s[8:11], 0 offen lds
    s_mov_b32 m0, 82944
    s_mov_b32 s46, 1184256
    buffer_load_dwordx4 v72, s[8:11], s46 offen lds
    s_mov_b32 m0, 83968
    s_mov_b32 s46, 1188864
    buffer_load_dwordx4 v72, s[8:11], s46 offen lds
    s_mov_b32 m0, 84992
    s_mov_b32 s46, 1193472
    buffer_load_dwordx4 v72, s[8:11], s46 offen lds
    s_branch k3_epi_25
k3_nt_27:
    v_and_b32 v2, 15, v1
    v_lshrrev_b32 v3, 4, v1
    v_xor_b32 v3, v3, v2
    v_lshlrev_b32 v2, 11, v2
    v_add_u32 v2, s42, v2
    v_xor_b32 v8, 0, v3
    v_lshl_add_u32 v8, v8, 4, v2
    v_xor_b32 v9, 4, v3
    v_lshl_add_u32 v9, v9, 4, v2
    v_xor_b32 v10, 8, v3
    v_lshl_add_u32 v10, v10, 4, v2
    v_xor_b32 v11, 12, v3
    v_lshl_add_u32 v11, v11, 4, v2
    s_waitcnt vmcnt(8)
    s_cmp_lt_u32 s30, s40
    s_cbranch_scc1 k3_j_29
    s_waitcnt vmcnt(0)
k3_j_29:
    s_barrier
    s_cmp_ge_u32 s30, s40
    s_cbranch_scc1 k3_epi_25
    s_cmp_eq_u32 s29, 0
    s_cbranch_scc1 k3_ed_31
    ds_read_b128 v[72:75], v8 offset:0
    ds_read_b128 v[80:83], v9 offset:0
    ds_read_b128 v[88:91], v10 offset:0
    ds_read_b128 v[96:99], v11 offset:0
    buffer_load_dwordx4 v[136:139], v5, s[16:19], s39 offen offset:0
    buffer_load_dwordx4 v[140:143], v5, s[16:19], s39 offen offset:1024
    s_waitcnt lgkmcnt(3)
    v_xor_b32 v76, s41, v72
    v_xor_b32 v77, s41, v73
    v_xor_b32 v78, s41, v74
    v_xor_b32 v79, s41, v75
    s_waitcnt vmcnt(9)
    v_mfma_f32_16x16x32_bf16 v[60:63], v[104:107], v[72:75], 0
    v_mfma_f32_16x16x32_bf16 v[64:67], v[104:107], v[76:79], 0
    ds_read_b128 v[72:75], v8 offset:256
    buffer_load_dwordx4 v[144:147], v5, s[16:19], s39 offen offset:2048
    buffer_load_dwordx4 v[148:151], v5, s[16:19], s39 offen offset:3072
    s_add_u32 s39, s39, 4096
    s_waitcnt lgkmcnt(3)
    v_xor_b32 v84, s41, v80
    v_xor_b32 v85, s41, v81
    v_xor_b32 v86, s41, v82
    v_xor_b32 v87, s41, v83
    s_waitcnt vmcnt(10)
    v_mfma_f32_16x16x32_bf16 v[60:63], v[108:111], v[80:83], v[60:63]
    v_mfma_f32_16x16x32_bf16 v[64:67], v[108:111], v[84:87], v[64:67]
    ds_read_b128 v[80:83], v9 offset:256
    buffer_load_dwordx4 v[152:155], v5, s[16:19], s39 offen offset:0
    buffer_load_dwordx4 v[156:159], v5, s[16:19], s39 offen offset:1024
    s_waitcnt lgkmcnt(3)
    v_xor_b32 v92, s41, v88
    v_xor_b32 v93, s41, v89
    v_xor_b32 v94, s41, v90
    v_xor_b32 v95, s41, v91
    s_waitcnt vmcnt(11)
    v_mfma_f32_16x16x32_bf16 v[60:63], v[112:115], v[88:91], v[60:63]
    v_mfma_f32_16x16x32_bf16 v[64:67], v[112:115], v[92:95], v[64:67]
    ds_read_b128 v[88:91], v10 offset:256
    buffer_load_dwordx4 v[160:163], v5, s[16:19], s39 offen offset:2048
    buffer_load_dwordx4 v[164:167], v5, s[16:19], s39 offen offset:3072
    s_add_u32 s39, s39, 4096
    s_waitcnt lgkmcnt(3)
    v_xor_b32 v100, s41, v96
    v_xor_b32 v101, s41, v97
    v_xor_b32 v102, s41, v98
    v_xor_b32 v103, s41, v99
    s_waitcnt vmcnt(12)
    v_mfma_f32_16x16x32_bf16 v[60:63], v[116:119], v[96:99], v[60:63]
    v_mfma_f32_16x16x32_bf16 v[64:67], v[116:119], v[100:103], v[64:67]
    ds_read_b128 v[96:99], v11 offset:256
    buffer_load_dwordx4 v[168:171], v5, s[16:19], s39 offen offset:0
    buffer_load_dwordx4 v[172:175], v5, s[16:19], s39 offen offset:1024
    s_waitcnt lgkmcnt(3)
    v_xor_b32 v76, s41, v72
    v_xor_b32 v77, s41, v73
    v_xor_b32 v78, s41, v74
    v_xor_b32 v79, s41, v75
    s_waitcnt vmcnt(13)
    v_mfma_f32_16x16x32_bf16 v[60:63], v[120:123], v[72:75], v[60:63]
    v_mfma_f32_16x16x32_bf16 v[64:67], v[120:123], v[76:79], v[64:67]
    ds_read_b128 v[72:75], v8 offset:512
    buffer_load_dwordx4 v[176:179], v5, s[16:19], s39 offen offset:2048
    buffer_load_dwordx4 v[180:183], v5, s[16:19], s39 offen offset:3072
    s_add_u32 s39, s39, 4096
    s_waitcnt lgkmcnt(3)
    v_xor_b32 v84, s41, v80
    v_xor_b32 v85, s41, v81
    v_xor_b32 v86, s41, v82
    v_xor_b32 v87, s41, v83
    s_waitcnt vmcnt(14)
    v_mfma_f32_16x16x32_bf16 v[60:63], v[124:127], v[80:83], v[60:63]
    v_mfma_f32_16x16x32_bf16 v[64:67], v[124:127], v[84:87], v[64:67]
    ds_read_b128 v[80:83], v9 offset:512
    buffer_load_dwordx4 v[184:187], v5, s[16:19], s39 offen offset:0
    buffer_load_dwordx4 v[188:191], v5, s[16:19], s39 offen offset:1024
    s_waitcnt lgkmcnt(3)
    v_xor_b32 v92, s41, v88
    v_xor_b32 v93, s41, v89
    v_xor_b32 v94, s41, v90
    v_xor_b32 v95, s41, v91
    s_waitcnt vmcnt(15)
    v_mfma_f32_16x16x32_bf16 v[60:63], v[128:131], v[88:91], v[60:63]
    v_mfma_f32_16x16x32_bf16 v[64:67], v[128:131], v[92:95], v[64:67]
    ds_read_b128 v[88:91], v10 offset:512
    buffer_load_dwordx4 v[192:195], v5, s[16:19], s39 offen offset:2048
    buffer_load_dwordx4 v[196:199], v5, s[16:19], s39 offen offset:3072
    s_add_u32 s39, s39, 4096
    s_waitcnt lgkmcnt(3)
    v_xor_b32 v100, s41, v96
    v_xor_b32 v101, s41, v97
    v_xor_b32 v102, s41, v98
    v_xor_b32 v103, s41, v99
    s_waitcnt vmcnt(16)
    v_mfma_f32_16x16x32_bf16 v[60:63], v[132:135], v[96:99], v[60:63]
    v_mfma_f32_16x16x32_bf16 v[64:67], v[132:135], v[100:103], v[64:67]
    ds_read_b128 v[96:99], v11 offset:512
    buffer_load_dwordx4 v[200:203], v5, s[16:19], s39 offen offset:0
    buffer_load_dwordx4 v[204:207], v5, s[16:19], s39 offen offset:1024
    s_waitcnt lgkmcnt(3)
    v_xor_b32 v76, s41, v72
    v_xor_b32 v77, s41, v73
    v_xor_b32 v78, s41, v74
    v_xor_b32 v79, s41, v75
    s_waitcnt vmcnt(17)
    v_mfma_f32_16x16x32_bf16 v[60:63], v[136:139], v[72:75], v[60:63]
    v_mfma_f32_16x16x32_bf16 v[64:67], v[136:139], v[76:79], v[64:67]
    ds_read_b128 v[72:75], v8 offset:768
    buffer_load_dwordx4 v[208:211], v5, s[16:19], s39 offen offset:2048
    buffer_load_dwordx4 v[212:215], v5, s[16:19], s39 offen offset:3072
    s_add_u32 s39, s39, 4096
    s_waitcnt lgkmcnt(3)
    v_xor_b32 v84, s41, v80
    v_xor_b32 v85, s41, v81
    v_xor_b32 v86, s41, v82
    v_xor_b32 v87, s41, v83
    s_waitcnt vmcnt(18)
    v_mfma_f32_16x16x32_bf16 v[60:63], v[140:143], v[80:83], v[60:63]
    v_mfma_f32_16x16x32_bf16 v[64:67], v[140:143], v[84:87], v[64:67]
    ds_read_b128 v[80:83], v9 offset:768
    buffer_load_dwordx4 v[216:219], v5, s[16:19], s39 offen offset:0
    buffer_load_dwordx4 v[220:223], v5, s[16:19], s39 offen offset:1024
    s_waitcnt lgkmcnt(3)
    v_xor_b32 v92, s41, v88
    v_xor_b32 v93, s41, v89
    v_xor_b32 v94, s41, v90
    v_xor_b32 v95, s41, v91
    s_waitcnt vmcnt(19)
    v_mfma_f32_16x16x32_bf16 v[60:63], v[144:147], v[88:91], v[60:63]
    v_mfma_f32_16x16x32_bf16 v[64:67], v[144:147], v[92:95], v[64:67]
    ds_read_b128 v[88:91], v10 offset:768
    buffer_load_dwordx4 v[224:227], v5, s[16:19], s39 offen offset:2048
    buffer_load_dwordx4 v[228:231], v5, s[16:19], s39 offen offset:3072
    s_add_u32 s39, s39, 4096
    s_waitcnt lgkmcnt(3)
    v_xor_b32 v100, s41, v96
    v_xor_b32 v101, s41, v97
    v_xor_b32 v102, s41, v98
    v_xor_b32 v103, s41, v99
    s_waitcnt vmcnt(20)
    v_mfma_f32_16x16x32_bf16 v[60:63], v[148:151], v[96:99], v[60:63]
    v_mfma_f32_16x16x32_bf16 v[64:67], v[148:151], v[100:103], v[64:67]
    ds_read_b128 v[96:99], v11 offset:768
    s_waitcnt lgkmcnt(3)
    v_xor_b32 v76, s41, v72
    v_xor_b32 v77, s41, v73
    v_xor_b32 v78, s41, v74
    v_xor_b32 v79, s41, v75
    s_waitcnt vmcnt(19)
    v_mfma_f32_16x16x32_bf16 v[60:63], v[152:155], v[72:75], v[60:63]
    v_mfma_f32_16x16x32_bf16 v[64:67], v[152:155], v[76:79], v[64:67]
    ds_read_b128 v[72:75], v8 offset:1024
    s_waitcnt lgkmcnt(3)
    v_xor_b32 v84, s41, v80
    v_xor_b32 v85, s41, v81
    v_xor_b32 v86, s41, v82
    v_xor_b32 v87, s41, v83
    s_waitcnt vmcnt(18)
    v_mfma_f32_16x16x32_bf16 v[60:63], v[156:159], v[80:83], v[60:63]
    v_mfma_f32_16x16x32_bf16 v[64:67], v[156:159], v[84:87], v[64:67]
    ds_read_b128 v[80:83], v9 offset:1024
    s_waitcnt lgkmcnt(3)
    v_xor_b32 v92, s41, v88
    v_xor_b32 v93, s41, v89
    v_xor_b32 v94, s41, v90
    v_xor_b32 v95, s41, v91
    s_waitcnt vmcnt(17)
    v_mfma_f32_16x16x32_bf16 v[60:63], v[160:163], v[88:91], v[60:63]
    v_mfma_f32_16x16x32_bf16 v[64:67], v[160:163], v[92:95], v[64:67]
    ds_read_b128 v[88:91], v10 offset:1024
    s_waitcnt lgkmcnt(3)
    v_xor_b32 v100, s41, v96
    v_xor_b32 v101, s41, v97
    v_xor_b32 v102, s41, v98
    v_xor_b32 v103, s41, v99
    s_waitcnt vmcnt(16)
    v_mfma_f32_16x16x32_bf16 v[60:63], v[164:167], v[96:99], v[60:63]
    v_mfma_f32_16x16x32_bf16 v[64:67], v[164:167], v[100:103], v[64:67]
    ds_read_b128 v[96:99], v11 offset:1024
    s_waitcnt lgkmcnt(3)
    v_xor_b32 v76, s41, v72
    v_xor_b32 v77, s41, v73
    v_xor_b32 v78, s41, v74
    v_xor_b32 v79, s41, v75
    s_waitcnt vmcnt(15)
    v_mfma_f32_16x16x32_bf16 v[60:63], v[168:171], v[72:75], v[60:63]
    v_mfma_f32_16x16x32_bf16 v[64:67], v[168:171], v[76:79], v[64:67]
    ds_read_b128 v[72:75], v8 offset:1280
    s_waitcnt lgkmcnt(3)
    v_xor_b32 v84, s41, v80
    v_xor_b32 v85, s41, v81
    v_xor_b32 v86, s41, v82
    v_xor_b32 v87, s41, v83
    s_waitcnt vmcnt(14)
    v_mfma_f32_16x16x32_bf16 v[60:63], v[172:175], v[80:83], v[60:63]
    v_mfma_f32_16x16x32_bf16 v[64:67], v[172:175], v[84:87], v[64:67]
    ds_read_b128 v[80:83], v9 offset:1280
    s_waitcnt lgkmcnt(3)
    v_xor_b32 v92, s41, v88
    v_xor_b32 v93, s41, v89
    v_xor_b32 v94, s41, v90
    v_xor_b32 v95, s41, v91
    s_waitcnt vmcnt(13)
    v_mfma_f32_16x16x32_bf16 v[60:63], v[176:179], v[88:91], v[60:63]
    v_mfma_f32_16x16x32_bf16 v[64:67], v[176:179], v[92:95], v[64:67]
    ds_read_b128 v[88:91], v10 offset:1280
    s_waitcnt lgkmcnt(3)
    v_xor_b32 v100, s41, v96
    v_xor_b32 v101, s41, v97
    v_xor_b32 v102, s41, v98
    v_xor_b32 v103, s41, v99
    s_waitcnt vmcnt(12)
    v_mfma_f32_16x16x32_bf16 v[60:63], v[180:183], v[96:99], v[60:63]
    v_mfma_f32_16x16x32_bf16 v[64:67], v[180:183], v[100:103], v[64:67]
    ds_read_b128 v[96:99], v11 offset:1280
    s_waitcnt lgkmcnt(3)
    v_xor_b32 v76, s41, v72
    v_xor_b32 v77, s41, v73
    v_xor_b32 v78, s41, v74
    v_xor_b32 v79, s41, v75
    s_waitcnt vmcnt(11)
    v_mfma_f32_16x16x32_bf16 v[60:63], v[184:187], v[72:75], v[60:63]
    v_mfma_f32_16x16x32_bf16 v[64:67], v[184:187], v[76:79], v[64:67]
    ds_read_b128 v[72:75], v8 offset:1536
    s_waitcnt lgkmcnt(3)
    v_xor_b32 v84, s41, v80
    v_xor_b32 v85, s41, v81
    v_xor_b32 v86, s41, v82
    v_xor_b32 v87, s41, v83
    s_waitcnt vmcnt(10)
    v_mfma_f32_16x16x32_bf16 v[60:63], v[188:191], v[80:83], v[60:63]
    v_mfma_f32_16x16x32_bf16 v[64:67], v[188:191], v[84:87], v[64:67]
    ds_read_b128 v[80:83], v9 offset:1536
    s_waitcnt lgkmcnt(3)
    v_xor_b32 v92, s41, v88
    v_xor_b32 v93, s41, v89
    v_xor_b32 v94, s41, v90
    v_xor_b32 v95, s41, v91
    s_waitcnt vmcnt(9)
    v_mfma_f32_16x16x32_bf16 v[60:63], v[192:195], v[88:91], v[60:63]
    v_mfma_f32_16x16x32_bf16 v[64:67], v[192:195], v[92:95], v[64:67]
    ds_read_b128 v[88:91], v10 offset:1536
    s_waitcnt lgkmcnt(3)
    v_xor_b32 v100, s41, v96
    v_xor_b32 v101, s41, v97
    v_xor_b32 v102, s41, v98
    v_xor_b32 v103, s41, v99
    s_waitcnt vmcnt(8)
    v_mfma_f32_16x16x32_bf16 v[60:63], v[196:199], v[96:99], v[60:63]
    v_mfma_f32_16x16x32_bf16 v[64:67], v[196:199], v[100:103], v[64:67]
    ds_read_b128 v[96:99], v11 offset:1536
    s_waitcnt lgkmcnt(3)
    v_xor_b32 v76, s41, v72
    v_xor_b32 v77, s41, v73
    v_xor_b32 v78, s41, v74
    v_xor_b32 v79, s41, v75
    s_waitcnt vmcnt(7)
    v_mfma_f32_16x16x32_bf16 v[60:63], v[200:203], v[72:75], v[60:63]
    v_mfma_f32_16x16x32_bf16 v[64:67], v[200:203], v[76:79], v[64:67]
    ds_read_b128 v[72:75], v8 offset:1792
    s_waitcnt lgkmcnt(3)
    v_xor_b32 v84, s41, v80
    v_xor_b32 v85, s41, v81
    v_xor_b32 v86, s41, v82
    v_xor_b32 v87, s41, v83
    s_waitcnt vmcnt(6)
    v_mfma_f32_16x16x32_bf16 v[60:63], v[204:207], v[80:83], v[60:63]
    v_mfma_f32_16x16x32_bf16 v[64:67], v[204:207], v[84:87], v[64:67]
    ds_read_b128 v[80:83], v9 offset:1792
    s_waitcnt lgkmcnt(3)
    v_xor_b32 v92, s41, v88
    v_xor_b32 v93, s41, v89
    v_xor_b32 v94, s41, v90
    v_xor_b32 v95, s41, v91
    s_waitcnt vmcnt(5)
    v_mfma_f32_16x16x32_bf16 v[60:63], v[208:211], v[88:91], v[60:63]
    v_mfma_f32_16x16x32_bf16 v[64:67], v[208:211], v[92:95], v[64:67]
    ds_read_b128 v[88:91], v10 offset:1792
    s_waitcnt lgkmcnt(3)
    v_xor_b32 v100, s41, v96
    v_xor_b32 v101, s41, v97
    v_xor_b32 v102, s41, v98
    v_xor_b32 v103, s41, v99
    s_waitcnt vmcnt(4)
    v_mfma_f32_16x16x32_bf16 v[60:63], v[212:215], v[96:99], v[60:63]
    v_mfma_f32_16x16x32_bf16 v[64:67], v[212:215], v[100:103], v[64:67]
    ds_read_b128 v[96:99], v11 offset:1792
    s_waitcnt lgkmcnt(3)
    v_xor_b32 v76, s41, v72
    v_xor_b32 v77, s41, v73
    v_xor_b32 v78, s41, v74
    v_xor_b32 v79, s41, v75
    s_waitcnt vmcnt(3)
    v_mfma_f32_16x16x32_bf16 v[60:63], v[216:219], v[72:75], v[60:63]
    v_mfma_f32_16x16x32_bf16 v[64:67], v[216:219], v[76:79], v[64:67]
    s_waitcnt lgkmcnt(2)
    v_xor_b32 v84, s41, v80
    v_xor_b32 v85, s41, v81
    v_xor_b32 v86, s41, v82
    v_xor_b32 v87, s41, v83
    s_waitcnt vmcnt(2)
    v_mfma_f32_16x16x32_bf16 v[60:63], v[220:223], v[80:83], v[60:63]
    v_mfma_f32_16x16x32_bf16 v[64:67], v[220:223], v[84:87], v[64:67]
    s_waitcnt lgkmcnt(1)
    v_xor_b32 v92, s41, v88
    v_xor_b32 v93, s41, v89
    v_xor_b32 v94, s41, v90
    v_xor_b32 v95, s41, v91
    s_waitcnt vmcnt(1)
    v_mfma_f32_16x16x32_bf16 v[60:63], v[224:227], v[88:91], v[60:63]
    v_mfma_f32_16x16x32_bf16 v[64:67], v[224:227], v[92:95], v[64:67]
    s_waitcnt lgkmcnt(0)
    v_xor_b32 v100, s41, v96
    v_xor_b32 v101, s41, v97
    v_xor_b32 v102, s41, v98
    v_xor_b32 v103, s41, v99
    s_waitcnt vmcnt(0)
    v_mfma_f32_16x16x32_bf16 v[60:63], v[228:231], v[96:99], v[60:63]
    v_mfma_f32_16x16x32_bf16 v[64:67], v[228:231], v[100:103], v[64:67]
    s_branch k3_ne_30
k3_ed_31:
    v_lshrrev_b32 v6, 4, v1
    v_lshlrev_b32 v6, 4, v6
    s_lshr_b32 s42, s42, 4
    s_add_u32 s42, s42, 65536
    v_add_u32 v6, s42, v6
    ds_read_b128 v[72:75], v8 offset:0
    ds_read_b128 v[32:35], v6 offset:0
    ds_read_b128 v[80:83], v9 offset:0
    ds_read_b128 v[36:39], v6 offset:64
    ds_read_b128 v[88:91], v10 offset:0
    ds_read_b128 v[40:43], v6 offset:128
    ds_read_b128 v[96:99], v11 offset:0
    ds_read_b128 v[44:47], v6 offset:192
    buffer_load_dwordx4 v[136:139], v5, s[16:19], s39 offen offset:0
    buffer_load_dwordx4 v[140:143], v5, s[16:19], s39 offen offset:1024
    s_waitcnt lgkmcnt(6)
    v_xor_b32 v76, s41, v72
    v_xor_b32 v77, s41, v73
    v_xor_b32 v78, s41, v74
    v_xor_b32 v79, s41, v75
    s_waitcnt vmcnt(9)
    v_mfma_f32_16x16x32_bf16 v[60:63], v[104:107], v[72:75], 0
    v_mfma_f32_16x16x32_bf16 v[64:67], v[104:107], v[76:79], 0
    v_mfma_f32_16x16x32_bf16 v[68:71], v[104:107], v[32:35], 0
    ds_read_b128 v[72:75], v8 offset:256
    ds_read_b128 v[32:35], v6 offset:256
    buffer_load_dwordx4 v[144:147], v5, s[16:19], s39 offen offset:2048
    buffer_load_dwordx4 v[148:151], v5, s[16:19], s39 offen offset:3072
    s_add_u32 s39, s39, 4096
    s_waitcnt lgkmcnt(6)
    v_xor_b32 v84, s41, v80
    v_xor_b32 v85, s41, v81
    v_xor_b32 v86, s41, v82
    v_xor_b32 v87, s41, v83
    s_waitcnt vmcnt(10)
    v_mfma_f32_16x16x32_bf16 v[60:63], v[108:111], v[80:83], v[60:63]
    v_mfma_f32_16x16x32_bf16 v[64:67], v[108:111], v[84:87], v[64:67]
    v_mfma_f32_16x16x32_bf16 v[68:71], v[108:111], v[36:39], v[68:71]
    ds_read_b128 v[80:83], v9 offset:256
    ds_read_b128 v[36:39], v6 offset:320
    buffer_load_dwordx4 v[152:155], v5, s[16:19], s39 offen offset:0
    buffer_load_dwordx4 v[156:159], v5, s[16:19], s39 offen offset:1024
    s_waitcnt lgkmcnt(6)
    v_xor_b32 v92, s41, v88
    v_xor_b32 v93, s41, v89
    v_xor_b32 v94, s41, v90
    v_xor_b32 v95, s41, v91
    s_waitcnt vmcnt(11)
    v_mfma_f32_16x16x32_bf16 v[60:63], v[112:115], v[88:91], v[60:63]
    v_mfma_f32_16x16x32_bf16 v[64:67], v[112:115], v[92:95], v[64:67]
    v_mfma_f32_16x16x32_bf16 v[68:71], v[112:115], v[40:43], v[68:71]
    ds_read_b128 v[88:91], v10 offset:256
    ds_read_b128 v[40:43], v6 offset:384
    buffer_load_dwordx4 v[160:163], v5, s[16:19], s39 offen offset:2048
    buffer_load_dwordx4 v[164:167], v5, s[16:19], s39 offen offset:3072
    s_add_u32 s39, s39, 4096
    s_waitcnt lgkmcnt(6)
    v_xor_b32 v100, s41, v96
    v_xor_b32 v101, s41, v97
    v_xor_b32 v102, s41, v98
    v_xor_b32 v103, s41, v99
    s_waitcnt vmcnt(12)
    v_mfma_f32_16x16x32_bf16 v[60:63], v[116:119], v[96:99], v[60:63]
    v_mfma_f32_16x16x32_bf16 v[64:67], v[116:119], v[100:103], v[64:67]
    v_mfma_f32_16x16x32_bf16 v[68:71], v[116:119], v[44:47], v[68:71]
    ds_read_b128 v[96:99], v11 offset:256
    ds_read_b128 v[44:47], v6 offset:448
    buffer_load_dwordx4 v[168:171], v5, s[16:19], s39 offen offset:0
    buffer_load_dwordx4 v[172:175], v5, s[16:19], s39 offen offset:1024
    s_waitcnt lgkmcnt(6)
    v_xor_b32 v76, s41, v72
    v_xor_b32 v77, s41, v73
    v_xor_b32 v78, s41, v74
    v_xor_b32 v79, s41, v75
    s_waitcnt vmcnt(13)
    v_mfma_f32_16x16x32_bf16 v[60:63], v[120:123], v[72:75], v[60:63]
    v_mfma_f32_16x16x32_bf16 v[64:67], v[120:123], v[76:79], v[64:67]
    v_mfma_f32_16x16x32_bf16 v[68:71], v[120:123], v[32:35], v[68:71]
    ds_read_b128 v[72:75], v8 offset:512
    ds_read_b128 v[32:35], v6 offset:512
    buffer_load_dwordx4 v[176:179], v5, s[16:19], s39 offen offset:2048
    buffer_load_dwordx4 v[180:183], v5, s[16:19], s39 offen offset:3072
    s_add_u32 s39, s39, 4096
    s_waitcnt lgkmcnt(6)
    v_xor_b32 v84, s41, v80
    v_xor_b32 v85, s41, v81
    v_xor_b32 v86, s41, v82
    v_xor_b32 v87, s41, v83
    s_waitcnt vmcnt(14)
    v_mfma_f32_16x16x32_bf16 v[60:63], v[124:127], v[80:83], v[60:63]
    v_mfma_f32_16x16x32_bf16 v[64:67], v[124:127], v[84:87], v[64:67]
    v_mfma_f32_16x16x32_bf16 v[68:71], v[124:127], v[36:39], v[68:71]
    ds_read_b128 v[80:83], v9 offset:512
    ds_read_b128 v[36:39], v6 offset:576
    buffer_load_dwordx4 v[184:187], v5, s[16:19], s39 offen offset:0
    buffer_load_dwordx4 v[188:191], v5, s[16:19], s39 offen offset:1024
    s_waitcnt lgkmcnt(6)
    v_xor_b32 v92, s41, v88
    v_xor_b32 v93, s41, v89
    v_xor_b32 v94, s41, v90
    v_xor_b32 v95, s41, v91
    s_waitcnt vmcnt(15)
    v_mfma_f32_16x16x32_bf16 v[60:63], v[128:131], v[88:91], v[60:63]
    v_mfma_f32_16x16x32_bf16 v[64:67], v[128:131], v[92:95], v[64:67]
    v_mfma_f32_16x16x32_bf16 v[68:71], v[128:131], v[40:43], v[68:71]
    ds_read_b128 v[88:91], v10 offset:512
    ds_read_b128 v[40:43], v6 offset:640
    buffer_load_dwordx4 v[192:195], v5, s[16:19], s39 offen offset:2048
    buffer_load_dwordx4 v[196:199], v5, s[16:19], s39 offen offset:3072
    s_add_u32 s39, s39, 4096
    s_waitcnt lgkmcnt(6)
    v_xor_b32 v100, s41, v96
    v_xor_b32 v101, s41, v97
    v_xor_b32 v102, s41, v98
    v_xor_b32 v103, s41, v99
    s_waitcnt vmcnt(16)
    v_mfma_f32_16x16x32_bf16 v[60:63], v[132:135], v[96:99], v[60:63]
    v_mfma_f32_16x16x32_bf16 v[64:67], v[132:135], v[100:103], v[64:67]
    v_mfma_f32_16x16x32_bf16 v[68:71], v[132:135], v[44:47], v[68:71]
    ds_read_b128 v[96:99], v11 offset:512
    ds_read_b128 v[44:47], v6 offset:704
    buffer_load_dwordx4 v[200:203], v5, s[16:19], s39 offen offset:0
    buffer_load_dwordx4 v[204:207], v5, s[16:19], s39 offen offset:1024
    s_waitcnt lgkmcnt(6)
    v_xor_b32 v76, s41, v72
    v_xor_b32 v77, s41, v73
    v_xor_b32 v78, s41, v74
    v_xor_b32 v79, s41, v75
    s_waitcnt vmcnt(17)
    v_mfma_f32_16x16x32_bf16 v[60:63], v[136:139], v[72:75], v[60:63]
    v_mfma_f32_16x16x32_bf16 v[64:67], v[136:139], v[76:79], v[64:67]
    v_mfma_f32_16x16x32_bf16 v[68:71], v[136:139], v[32:35], v[68:71]
    ds_read_b128 v[72:75], v8 offset:768
    ds_read_b128 v[32:35], v6 offset:768
    buffer_load_dwordx4 v[208:211], v5, s[16:19], s39 offen offset:2048
    buffer_load_dwordx4 v[212:215], v5, s[16:19], s39 offen offset:3072
    s_add_u32 s39, s39, 4096
    s_waitcnt lgkmcnt(6)
    v_xor_b32 v84, s41, v80
    v_xor_b32 v85, s41, v81
    v_xor_b32 v86, s41, v82
    v_xor_b32 v87, s41, v83
    s_waitcnt vmcnt(18)
    v_mfma_f32_16x16x32_bf16 v[60:63], v[140:143], v[80:83], v[60:63]
    v_mfma_f32_16x16x32_bf16 v[64:67], v[140:143], v[84:87], v[64:67]
    v_mfma_f32_16x16x32_bf16 v[68:71], v[140:143], v[36:39], v[68:71]
    ds_read_b128 v[80:83], v9 offset:768
    ds_read_b128 v[36:39], v6 offset:832
    buffer_load_dwordx4 v[216:219], v5, s[16:19], s39 offen offset:0
    buffer_load_dwordx4 v[220:223], v5, s[16:19], s39 offen offset:1024
    s_waitcnt lgkmcnt(6)
    v_xor_b32 v92, s41, v88
    v_xor_b32 v93, s41, v89
    v_xor_b32 v94, s41, v90
    v_xor_b32 v95, s41, v91
    s_waitcnt vmcnt(19)
    v_mfma_f32_16x16x32_bf16 v[60:63], v[144:147], v[88:91], v[60:63]
    v_mfma_f32_16x16x32_bf16 v[64:67], v[144:147], v[92:95], v[64:67]
    v_mfma_f32_16x16x32_bf16 v[68:71], v[144:147], v[40:43], v[68:71]
    ds_read_b128 v[88:91], v10 offset:768
    ds_read_b128 v[40:43], v6 offset:896
    buffer_load_dwordx4 v[224:227], v5, s[16:19], s39 offen offset:2048
    buffer_load_dwordx4 v[228:231], v5, s[16:19], s39 offen offset:3072
    s_add_u32 s39, s39, 4096
    s_waitcnt lgkmcnt(6)
    v_xor_b32 v100, s41, v96
    v_xor_b32 v101, s41, v97
    v_xor_b32 v102, s41, v98
    v_xor_b32 v103, s41, v99
    s_waitcnt vmcnt(20)
    v_mfma_f32_16x16x32_bf16 v[60:63], v[148:151], v[96:99], v[60:63]
    v_mfma_f32_16x16x32_bf16 v[64:67], v[148:151], v[100:103], v[64:67]
    v_mfma_f32_16x16x32_bf16 v[68:71], v[148:151], v[44:47], v[68:71]
    ds_read_b128 v[96:99], v11 offset:768
    ds_read_b128 v[44:47], v6 offset:960
    s_waitcnt lgkmcnt(6)
    v_xor_b32 v76, s41, v72
    v_xor_b32 v77, s41, v73
    v_xor_b32 v78, s41, v74
    v_xor_b32 v79, s41, v75
    s_waitcnt vmcnt(19)
    v_mfma_f32_16x16x32_bf16 v[60:63], v[152:155], v[72:75], v[60:63]
    v_mfma_f32_16x16x32_bf16 v[64:67], v[152:155], v[76:79], v[64:67]
    v_mfma_f32_16x16x32_bf16 v[68:71], v[152:155], v[32:35], v[68:71]
    ds_read_b128 v[72:75], v8 offset:1024
    ds_read_b128 v[32:35], v6 offset:1024
    s_waitcnt lgkmcnt(6)
    v_xor_b32 v84, s41, v80
    v_xor_b32 v85, s41, v81
    v_xor_b32 v86, s41, v82
    v_xor_b32 v87, s41, v83
    s_waitcnt vmcnt(18)
    v_mfma_f32_16x16x32_bf16 v[60:63], v[156:159], v[80:83], v[60:63]
    v_mfma_f32_16x16x32_bf16 v[64:67], v[156:159], v[84:87], v[64:67]
    v_mfma_f32_16x16x32_bf16 v[68:71], v[156:159], v[36:39], v[68:71]
    ds_read_b128 v[80:83], v9 offset:1024
    ds_read_b128 v[36:39], v6 offset:1088
    s_waitcnt lgkmcnt(6)
    v_xor_b32 v92, s41, v88
    v_xor_b32 v93, s41, v89
    v_xor_b32 v94, s41, v90
    v_xor_b32 v95, s41, v91
    s_waitcnt vmcnt(17)
    v_mfma_f32_16x16x32_bf16 v[60:63], v[160:163], v[88:91], v[60:63]
    v_mfma_f32_16x16x32_bf16 v[64:67], v[160:163], v[92:95], v[64:67]
    v_mfma_f32_16x16x32_bf16 v[68:71], v[160:163], v[40:43], v[68:71]
    ds_read_b128 v[88:91], v10 offset:1024
    ds_read_b128 v[40:43], v6 offset:1152
    s_waitcnt lgkmcnt(6)
    v_xor_b32 v100, s41, v96
    v_xor_b32 v101, s41, v97
    v_xor_b32 v102, s41, v98
    v_xor_b32 v103, s41, v99
    s_waitcnt vmcnt(16)
    v_mfma_f32_16x16x32_bf16 v[60:63], v[164:167], v[96:99], v[60:63]
    v_mfma_f32_16x16x32_bf16 v[64:67], v[164:167], v[100:103], v[64:67]
    v_mfma_f32_16x16x32_bf16 v[68:71], v[164:167], v[44:47], v[68:71]
    ds_read_b128 v[96:99], v11 offset:1024
    ds_read_b128 v[44:47], v6 offset:1216
    s_waitcnt lgkmcnt(6)
    v_xor_b32 v76, s41, v72
    v_xor_b32 v77, s41, v73
    v_xor_b32 v78, s41, v74
    v_xor_b32 v79, s41, v75
    s_waitcnt vmcnt(15)
    v_mfma_f32_16x16x32_bf16 v[60:63], v[168:171], v[72:75], v[60:63]
    v_mfma_f32_16x16x32_bf16 v[64:67], v[168:171], v[76:79], v[64:67]
    v_mfma_f32_16x16x32_bf16 v[68:71], v[168:171], v[32:35], v[68:71]
    ds_read_b128 v[72:75], v8 offset:1280
    ds_read_b128 v[32:35], v6 offset:1280
    s_waitcnt lgkmcnt(6)
    v_xor_b32 v84, s41, v80
    v_xor_b32 v85, s41, v81
    v_xor_b32 v86, s41, v82
    v_xor_b32 v87, s41, v83
    s_waitcnt vmcnt(14)
    v_mfma_f32_16x16x32_bf16 v[60:63], v[172:175], v[80:83], v[60:63]
    v_mfma_f32_16x16x32_bf16 v[64:67], v[172:175], v[84:87], v[64:67]
    v_mfma_f32_16x16x32_bf16 v[68:71], v[172:175], v[36:39], v[68:71]
    ds_read_b128 v[80:83], v9 offset:1280
    ds_read_b128 v[36:39], v6 offset:1344
    s_waitcnt lgkmcnt(6)
    v_xor_b32 v92, s41, v88
    v_xor_b32 v93, s41, v89
    v_xor_b32 v94, s41, v90
    v_xor_b32 v95, s41, v91
    s_waitcnt vmcnt(13)
    v_mfma_f32_16x16x32_bf16 v[60:63], v[176:179], v[88:91], v[60:63]
    v_mfma_f32_16x16x32_bf16 v[64:67], v[176:179], v[92:95], v[64:67]
    v_mfma_f32_16x16x32_bf16 v[68:71], v[176:179], v[40:43], v[68:71]
    ds_read_b128 v[88:91], v10 offset:1280
    ds_read_b128 v[40:43], v6 offset:1408
    s_waitcnt lgkmcnt(6)
    v_xor_b32 v100, s41, v96
    v_xor_b32 v101, s41, v97
    v_xor_b32 v102, s41, v98
    v_xor_b32 v103, s41, v99
    s_waitcnt vmcnt(12)
    v_mfma_f32_16x16x32_bf16 v[60:63], v[180:183], v[96:99], v[60:63]
    v_mfma_f32_16x16x32_bf16 v[64:67], v[180:183], v[100:103], v[64:67]
    v_mfma_f32_16x16x32_bf16 v[68:71], v[180:183], v[44:47], v[68:71]
    ds_read_b128 v[96:99], v11 offset:1280
    ds_read_b128 v[44:47], v6 offset:1472
    s_waitcnt lgkmcnt(6)
    v_xor_b32 v76, s41, v72
    v_xor_b32 v77, s41, v73
    v_xor_b32 v78, s41, v74
    v_xor_b32 v79, s41, v75
    s_waitcnt vmcnt(11)
    v_mfma_f32_16x16x32_bf16 v[60:63], v[184:187], v[72:75], v[60:63]
    v_mfma_f32_16x16x32_bf16 v[64:67], v[184:187], v[76:79], v[64:67]
    v_mfma_f32_16x16x32_bf16 v[68:71], v[184:187], v[32:35], v[68:71]
    ds_read_b128 v[72:75], v8 offset:1536
    ds_read_b128 v[32:35], v6 offset:1536
    s_waitcnt lgkmcnt(6)
    v_xor_b32 v84, s41, v80
    v_xor_b32 v85, s41, v81
    v_xor_b32 v86, s41, v82
    v_xor_b32 v87, s41, v83
    s_waitcnt vmcnt(10)
    v_mfma_f32_16x16x32_bf16 v[60:63], v[188:191], v[80:83], v[60:63]
    v_mfma_f32_16x16x32_bf16 v[64:67], v[188:191], v[84:87], v[64:67]
    v_mfma_f32_16x16x32_bf16 v[68:71], v[188:191], v[36:39], v[68:71]
    ds_read_b128 v[80:83], v9 offset:1536
    ds_read_b128 v[36:39], v6 offset:1600
    s_waitcnt lgkmcnt(6)
    v_xor_b32 v92, s41, v88
    v_xor_b32 v93, s41, v89
    v_xor_b32 v94, s41, v90
    v_xor_b32 v95, s41, v91
    s_waitcnt vmcnt(9)
    v_mfma_f32_16x16x32_bf16 v[60:63], v[192:195], v[88:91], v[60:63]
    v_mfma_f32_16x16x32_bf16 v[64:67], v[192:195], v[92:95], v[64:67]
    v_mfma_f32_16x16x32_bf16 v[68:71], v[192:195], v[40:43], v[68:71]
    ds_read_b128 v[88:91], v10 offset:1536
    ds_read_b128 v[40:43], v6 offset:1664
    s_waitcnt lgkmcnt(6)
    v_xor_b32 v100, s41, v96
    v_xor_b32 v101, s41, v97
    v_xor_b32 v102, s41, v98
    v_xor_b32 v103, s41, v99
    s_waitcnt vmcnt(8)
    v_mfma_f32_16x16x32_bf16 v[60:63], v[196:199], v[96:99], v[60:63]
    v_mfma_f32_16x16x32_bf16 v[64:67], v[196:199], v[100:103], v[64:67]
    v_mfma_f32_16x16x32_bf16 v[68:71], v[196:199], v[44:47], v[68:71]
    ds_read_b128 v[96:99], v11 offset:1536
    ds_read_b128 v[44:47], v6 offset:1728
    s_waitcnt lgkmcnt(6)
    v_xor_b32 v76, s41, v72
    v_xor_b32 v77, s41, v73
    v_xor_b32 v78, s41, v74
    v_xor_b32 v79, s41, v75
    s_waitcnt vmcnt(7)
    v_mfma_f32_16x16x32_bf16 v[60:63], v[200:203], v[72:75], v[60:63]
    v_mfma_f32_16x16x32_bf16 v[64:67], v[200:203], v[76:79], v[64:67]
    v_mfma_f32_16x16x32_bf16 v[68:71], v[200:203], v[32:35], v[68:71]
    ds_read_b128 v[72:75], v8 offset:1792
    ds_read_b128 v[32:35], v6 offset:1792
    s_waitcnt lgkmcnt(6)
    v_xor_b32 v84, s41, v80
    v_xor_b32 v85, s41, v81
    v_xor_b32 v86, s41, v82
    v_xor_b32 v87, s41, v83
    s_waitcnt vmcnt(6)
    v_mfma_f32_16x16x32_bf16 v[60:63], v[204:207], v[80:83], v[60:63]
    v_mfma_f32_16x16x32_bf16 v[64:67], v[204:207], v[84:87], v[64:67]
    v_mfma_f32_16x16x32_bf16 v[68:71], v[204:207], v[36:39], v[68:71]
    ds_read_b128 v[80:83], v9 offset:1792
    ds_read_b128 v[36:39], v6 offset:1856
    s_waitcnt lgkmcnt(6)
    v_xor_b32 v92, s41, v88
    v_xor_b32 v93, s41, v89
    v_xor_b32 v94, s41, v90
    v_xor_b32 v95, s41, v91
    s_waitcnt vmcnt(5)
    v_mfma_f32_16x16x32_bf16 v[60:63], v[208:211], v[88:91], v[60:63]
    v_mfma_f32_16x16x32_bf16 v[64:67], v[208:211], v[92:95], v[64:67]
    v_mfma_f32_16x16x32_bf16 v[68:71], v[208:211], v[40:43], v[68:71]
    ds_read_b128 v[88:91], v10 offset:1792
    ds_read_b128 v[40:43], v6 offset:1920
    s_waitcnt lgkmcnt(6)
    v_xor_b32 v100, s41, v96
    v_xor_b32 v101, s41, v97
    v_xor_b32 v102, s41, v98
    v_xor_b32 v103, s41, v99
    s_waitcnt vmcnt(4)
    v_mfma_f32_16x16x32_bf16 v[60:63], v[212:215], v[96:99], v[60:63]
    v_mfma_f32_16x16x32_bf16 v[64:67], v[212:215], v[100:103], v[64:67]
    v_mfma_f32_16x16x32_bf16 v[68:71], v[212:215], v[44:47], v[68:71]
    ds_read_b128 v[96:99], v11 offset:1792
    ds_read_b128 v[44:47], v6 offset:1984
    s_waitcnt lgkmcnt(6)
    v_xor_b32 v76, s41, v72
    v_xor_b32 v77, s41, v73
    v_xor_b32 v78, s41, v74
    v_xor_b32 v79, s41, v75
    s_waitcnt vmcnt(3)
    v_mfma_f32_16x16x32_bf16 v[60:63], v[216:219], v[72:75], v[60:63]
    v_mfma_f32_16x16x32_bf16 v[64:67], v[216:219], v[76:79], v[64:67]
    v_mfma_f32_16x16x32_bf16 v[68:71], v[216:219], v[32:35], v[68:71]
    s_waitcnt lgkmcnt(4)
    v_xor_b32 v84, s41, v80
    v_xor_b32 v85, s41, v81
    v_xor_b32 v86, s41, v82
    v_xor_b32 v87, s41, v83
    s_waitcnt vmcnt(2)
    v_mfma_f32_16x16x32_bf16 v[60:63], v[220:223], v[80:83], v[60:63]
    v_mfma_f32_16x16x32_bf16 v[64:67], v[220:223], v[84:87], v[64:67]
    v_mfma_f32_16x16x32_bf16 v[68:71], v[220:223], v[36:39], v[68:71]
    s_waitcnt lgkmcnt(2)
    v_xor_b32 v92, s41, v88
    v_xor_b32 v93, s41, v89
    v_xor_b32 v94, s41, v90
    v_xor_b32 v95, s41, v91
    s_waitcnt vmcnt(1)
    v_mfma_f32_16x16x32_bf16 v[60:63], v[224:227], v[88:91], v[60:63]
    v_mfma_f32_16x16x32_bf16 v[64:67], v[224:227], v[92:95], v[64:67]
    v_mfma_f32_16x16x32_bf16 v[68:71], v[224:227], v[40:43], v[68:71]
    s_waitcnt lgkmcnt(0)
    v_xor_b32 v100, s41, v96
    v_xor_b32 v101, s41, v97
    v_xor_b32 v102, s41, v98
    v_xor_b32 v103, s41, v99
    s_waitcnt vmcnt(0)
    v_mfma_f32_16x16x32_bf16 v[60:63], v[228:231], v[96:99], v[60:63]
    v_mfma_f32_16x16x32_bf16 v[64:67], v[228:231], v[100:103], v[64:67]
    v_mfma_f32_16x16x32_bf16 v[68:71], v[228:231], v[44:47], v[68:71]
k3_ne_30:
    s_mul_i32 s46, s30, 3072
    s_add_u32 s46, s46, 87040
    v_add_u32 v2, s46, v4
    s_nop 7
    ds_write_b128 v2, v[60:63] offset:0
    ds_write_b128 v2, v[64:67] offset:1024
    ds_write_b128 v2, v[68:71] offset:2048
k3_epi_25:
    v_and_b32 v12, 31, v0
    v_lshrrev_b32 v13, 5, v0
    v_cmp_lt_u32 vcc, 5, v13
    v_subrev_u32 v2, 6, v13
    s_mov_b64 s[50:51], vcc
    v_cndmask_b32 v13, v13, v2, vcc
    v_and_b32 v2, 15, v12
    s_lshl_b32 s38, s29, 4
    v_add_u32 v2, s38, v2
    v_cmp_eq_u32 s[52:53], 0, v2
    v_sub_u32 v3, 1024, v2
    v_cmp_lt_u32 s[54:55], 15, v12
    s_and_b64 s[52:53], s[52:53], s[50:51]
    s_nop 0
    v_cndmask_b32 v17, v2, v3, s[54:55]
    v_sub_u32 v3, 2048, v17
    v_cndmask_b32 v15, v17, v3, s[50:51]
    v_add_u32 v3, 512, v17
    v_cndmask_b32 v15, v15, v3, s[52:53]
    s_mul_i32 s38, s28, 48
    v_lshl_add_u32 v16, v13, 3, s38
    v_cmp_eq_u32 s[56:57], 0, v16
    v_add_u32 v2, 32, v12
    v_cndmask_b32 v2, v12, v2, s[50:51]
    v_lshlrev_b32 v2, 8, v2
    v_add_u32 v2, 69632, v2
    v_lshl_add_u32 v18, v13, 4, v2
    v_lshlrev_b32 v3, 4, v13
    v_sub_u32 v19, v2, v3
    v_add_u32 v19, 208, v19
    v_add_u32 v20, 16, v19
    v_add_u32 v2, 240, v2
    v_cndmask_b32 v20, v20, v2, s[56:57]
    v_lshlrev_b32 v14, 5, v13
    v_add_u32 v14, 86016, v14
    v_lshrrev_b32 v2, 4, v12
    v_cndmask_b32 v2, v2, 2, s[52:53]
    v_lshlrev_b32 v2, 10, v2
    v_and_b32 v3, 15, v12
    v_lshl_add_u32 v2, v3, 4, v2
    v_add_u32 v73, 105472, v2
    v_lshrrev_b32 v3, 1, v13
    v_mul_u32_u24 v3, 3072, v3
    v_add_u32 v72, v2, v3
    v_and_b32 v3, 1, v13
    v_lshl_add_u32 v72, v3, 9, v72
    v_add_u32 v72, 87040, v72
    s_waitcnt vmcnt(0) lgkmcnt(0)
    s_barrier
    s_cmp_ge_u32 s30, 6
    s_cbranch_scc1 k3_end_23
    ds_read_b128 v[104:107], v72 offset:0
    ds_read_b128 v[108:111], v72 offset:256
    ds_read_b128 v[112:115], v72 offset:9216
    ds_read_b128 v[116:119], v72 offset:9472
    ds_read_b32 v76, v73
    ds_read_b128 v[48:51], v14 offset:512
    ds_read_b128 v[52:55], v14 offset:528
    v_mov_b32 v3, 86784
    ds_read_b32 v56, v3
    ds_read_b128 v[32:35], v14 offset:0
    ds_read_b128 v[40:43], v14 offset:256
    ds_read_b128 v[36:39], v14 offset:16
    ds_read_b128 v[44:47], v14 offset:272
    ds_read_b128 v[22:25], v18
    ds_read_b128 v[26:29], v19
    ds_read_u16 v30, v20
    v_lshlrev_b32 v74, 31, v17
    s_andn2_b64 s[58:59], s[52:53], s[54:55]
    s_andn2_b64 s[58:59], s[50:51], s[58:59]
    v_bfrev_b32 v2, 1
    v_cndmask_b32 v75, 0, v2, s[58:59]
    s_waitcnt lgkmcnt(7)
    v_xor_b32 v48, v74, v48
    v_xor_b32 v49, v74, v49
    v_xor_b32 v50, v74, v50
    v_xor_b32 v51, v74, v51
    v_xor_b32 v52, v74, v52
    v_xor_b32 v53, v74, v53
    v_xor_b32 v54, v74, v54
    v_xor_b32 v55, v74, v55
    v_xor_b32 v56, v74, v56
    v_add_f32 v104, v104, v48
    v_xor_b32 v112, v75, v112
    v_add_f32 v105, v105, v49
    v_xor_b32 v113, v75, v113
    v_add_f32 v106, v106, v50
    v_xor_b32 v114, v75, v114
    v_add_f32 v107, v107, v51
    v_xor_b32 v115, v75, v115
    v_add_f32 v108, v108, v52
    v_xor_b32 v116, v75, v116
    v_add_f32 v109, v109, v53
    v_xor_b32 v117, v75, v117
    v_add_f32 v110, v110, v54
    v_xor_b32 v118, v75, v118
    v_add_f32 v111, v111, v55
    v_xor_b32 v119, v75, v119
    v_add_f32 v76, v76, v56
    v_sub_f32 v120, v104, v112
    v_add_f32 v128, v104, v112
    v_sub_f32 v121, v105, v113
    v_add_f32 v129, v105, v113
    v_sub_f32 v122, v106, v114
    v_add_f32 v130, v106, v114
    v_sub_f32 v123, v107, v115
    v_add_f32 v131, v107, v115
    v_sub_f32 v124, v108, v116
    v_add_f32 v132, v108, v116
    v_sub_f32 v125, v109, v117
    v_add_f32 v133, v109, v117
    v_sub_f32 v126, v110, v118
    v_add_f32 v134, v110, v118
    v_sub_f32 v127, v111, v119
    v_add_f32 v135, v111, v119
    v_cndmask_b32 v128, v128, v76, s[56:57]
    s_waitcnt lgkmcnt(0)
    v_lshlrev_b32 v2, 5, v16
    v_lshrrev_b32 v3, 4, v15
    v_mul_u32_u24 v18, 18432, v3
    v_and_b32 v3, 15, v15
    v_lshl_add_u32 v18, v3, 4, v18
    v_add_u32 v18, v18, v2
    s_mov_b32 s38, 3145728
    s_mov_b32 s39, 3154944
    v_lshlrev_b32 v144, 16, v22
    v_and_b32 v145, 0xffff0000, v22
    v_lshlrev_b32 v146, 16, v23
    v_and_b32 v147, 0xffff0000, v23
    v_lshlrev_b32 v148, 16, v24
    v_and_b32 v149, 0xffff0000, v24
    v_lshlrev_b32 v150, 16, v25
    v_and_b32 v151, 0xffff0000, v25
    v_fmac_f32 v144, v120, v32
    v_fmac_f32 v145, v121, v33
    v_fmac_f32 v146, v122, v34
    v_fmac_f32 v147, v123, v35
    v_fmac_f32 v148, v124, v36
    v_fmac_f32 v149, v125, v37
    v_fmac_f32 v150, v126, v38
    v_fmac_f32 v151, v127, v39
    v_cvt_pk_bf16_f32 v152, v144, v145
    v_cvt_pk_bf16_f32 v153, v146, v147
    v_cvt_pk_bf16_f32 v154, v148, v149
    v_cvt_pk_bf16_f32 v155, v150, v151
    buffer_store_dwordx4 v[152:155], v18, s[16:19], s38 offen sc1
    v_lshlrev_b32 v144, 16, v30
    v_and_b32 v145, 0xffff0000, v29
    v_lshlrev_b32 v146, 16, v29
    v_and_b32 v147, 0xffff0000, v28
    v_lshlrev_b32 v148, 16, v28
    v_and_b32 v149, 0xffff0000, v27
    v_lshlrev_b32 v150, 16, v27
    v_and_b32 v151, 0xffff0000, v26
    v_fmac_f32 v144, v128, v40
    v_fmac_f32 v145, v129, v41
    v_fmac_f32 v146, v130, v42
    v_fmac_f32 v147, v131, v43
    v_fmac_f32 v148, v132, v44
    v_fmac_f32 v149, v133, v45
    v_fmac_f32 v150, v134, v46
    v_fmac_f32 v151, v135, v47
    v_cvt_pk_bf16_f32 v156, v144, v145
    v_cvt_pk_bf16_f32 v157, v146, v147
    v_cvt_pk_bf16_f32 v158, v148, v149
    v_cvt_pk_bf16_f32 v159, v150, v151
    buffer_store_dwordx4 v[156:159], v18, s[16:19], s39 offen sc1
    s_mov_b32 s38, 0x3f803f80
    v_mov_b32 v136, 0
    v_mov_b32 v137, 0
    v_mov_b32 v138, 0
    v_mov_b32 v139, 0
    v_dot2_f32_bf16 v136, v152, s38, v136
    v_dot2_f32_bf16 v137, v152, v152, v137
    v_dot2_f32_bf16 v138, v153, s38, v138
    v_dot2_f32_bf16 v139, v153, v153, v139
    v_dot2_f32_bf16 v136, v154, s38, v136
    v_dot2_f32_bf16 v137, v154, v154, v137
    v_dot2_f32_bf16 v138, v155, s38, v138
    v_dot2_f32_bf16 v139, v155, v155, v139
    v_dot2_f32_bf16 v136, v156, s38, v136
    v_dot2_f32_bf16 v137, v156, v156, v137
    v_dot2_f32_bf16 v138, v157, s38, v138
    v_dot2_f32_bf16 v139, v157, v157, v139
    v_dot2_f32_bf16 v136, v158, s38, v136
    v_dot2_f32_bf16 v137, v158, v158, v137
    v_dot2_f32_bf16 v138, v159, s38, v138
    v_dot2_f32_bf16 v139, v159, v159, v139
    v_lshlrev_b32 v2, 3, v0
    v_add_u32 v2, 108544, v2
    s_nop 1
    v_pk_add_f32 v[136:137], v[136:137], v[138:139]
    ds_write_b64 v2, v[136:137]
    s_waitcnt lgkmcnt(0)
    s_barrier
    s_cmp_eq_u32 s30, 3
    s_cselect_b32 s38, 0, s30
    s_cmp_lg_u32 s38, 0
    s_cbranch_scc1 k3_end_23
    s_mov_b32 exec_hi, 0
    ds_read_b64 v[136:137], v2 offset:0
    ds_read_b64 v[138:139], v2 offset:256
    ds_read_b64 v[140:141], v2 offset:512
    ds_read_b64 v[142:143], v2 offset:768
    ds_read_b64 v[144:145], v2 offset:1024
    ds_read_b64 v[146:147], v2 offset:1280
    s_lshl_b32 s38, s28, 14
    s_add_u32 s38, s38, 131072
    v_lshlrev_b32 v3, 3, v15
    s_waitcnt lgkmcnt(0)
    v_pk_add_f32 v[136:137], v[136:137], v[138:139]
    v_pk_add_f32 v[136:137], v[136:137], v[140:141]
    v_pk_add_f32 v[136:137], v[136:137], v[142:143]
    v_pk_add_f32 v[136:137], v[136:137], v[144:145]
    v_pk_add_f32 v[136:137], v[136:137], v[146:147]
    buffer_store_dwordx2 v[136:137], v3, s[16:19], s38 offen
    s_endpgm
k3_pf_24:
    s_sub_u32 s32, s2, 192
    s_lshr_b32 s32, s32, 3
    v_lshlrev_b32 v1, 7, v0
    v_mov_b32 v3, 0x40000000
    s_and_b32 s33, s2, 1
    s_mul_i32 s33, s33, 294912
    v_lshl_add_u32 v6, v0, 3, s32
    v_lshlrev_b32 v7, 7, v6
    v_add_u32 v8, 753664, v7
    v_cmp_gt_u32 vcc, 2304, v6
    s_nop 1
    v_cndmask_b32 v8, v8, v7, vcc
    s_add_u32 s34, s33, 1048576
    v_add_u32 v9, 2326528, v7
    v_add_u32 v9, s33, v9
    v_add_u32 v10, 1572864, v7
    v_cmp_gt_u32 vcc, 512, v6
    s_nop 1
    v_cndmask_b32 v9, v10, v9, vcc
    v_cmp_gt_u32 vcc, 768, v6
    s_nop 1
    v_cndmask_b32 v9, v3, v9, vcc
    s_waitcnt lgkmcnt(0)
    buffer_load_dword v11, v8, s[16:19], s34 offen
    buffer_load_dword v12, v9, s[16:19], 0 offen
    s_and_b32 s31, s2, 7
    s_mul_i32 s31, s31, 663552
    s_mul_i32 s32, s32, 82944
    s_add_u32 s31, s31, s32
    v_cmp_gt_u32 vcc, 136, v0
    v_add_u32 v2, 65536, v1
    s_nop 0
    v_cndmask_b32 v2, v3, v2, vcc
    buffer_load_dword v4, v1, s[24:27], s31 offen
    buffer_load_dword v5, v2, s[24:27], s31 offen
    s_waitcnt vmcnt(0)
k3_end_23:
    s_endpgm
.globl k4_mlp_kernel
.p2align 8
.type k4_mlp_kernel,@function
k4_mlp_kernel:
    s_load_dwordx2 s[16:17], s[0:1], 96
    s_load_dwordx2 s[20:21], s[0:1], 48
    s_load_dwordx2 s[24:25], s[0:1], 56
    s_load_dwordx2 s[64:65], s[0:1], 80
    s_mov_b32 s18, 268435456
    s_mov_b32 s19, 0x00020000
    s_mov_b32 s22, 5308416
    s_mov_b32 s23, 0x00020000
    s_mov_b32 s26, 5308416
    s_mov_b32 s27, 0x00020000
    s_mov_b32 s66, 2359296
    s_mov_b32 s67, 0x00020000
    s_cmp_ge_u32 s2, 256
    s_cbranch_scc1 k4_end_32
    s_and_b32 s28, s2, 7
    s_lshr_b32 s29, s2, 3
    v_lshrrev_b32 v2, 6, v0
    v_and_b32 v3, 63, v0
    v_readfirstlane_b32 s30, v2
    v_lshlrev_b32 v1, 4, v3
    s_nop 1
    s_cmp_ge_u32 s30, 6
    s_cbranch_scc1 k4_norm_34
    s_cmp_ge_u32 s30, 4
    s_cbranch_scc1 k4_help_33
    v_lshrrev_b32 v2, 2, v3
    v_bfe_u32 v4, v3, 3, 2
    v_and_b32 v11, 3, v3
    v_lshlrev_b32 v11, 3, v11
    v_lshl_add_u32 v10, v2, 7, v11
    v_mul_u32_u24 v2, 1152, v2
    v_add_u32 v2, v2, v11
    s_mul_i32 s36, s30, 9
    s_add_u32 s37, s36, 0
    v_xor_b32 v5, s37, v4
    v_lshl_add_u32 v5, v5, 5, v2
    s_add_u32 s37, s36, 1
    v_xor_b32 v6, s37, v4
    v_lshl_add_u32 v6, v6, 5, v2
    s_add_u32 s37, s36, 2
    v_xor_b32 v7, s37, v4
    v_lshl_add_u32 v7, v7, 5, v2
    s_add_u32 s37, s36, 3
    v_xor_b32 v8, s37, v4
    v_lshl_add_u32 v8, v8, 5, v2
    s_and_b32 s37, s30, 2
    v_add_u32 v10, 73728, v10
    v_xor_b32 v2, s37, v4
    v_lshl_add_u32 v9, v2, 5, v10
    v_xor_b32 v2, 1, v2
    v_lshl_add_u32 v10, v2, 5, v10
    v_add_u32 v11, 147456, v1
    s_lshl_b32 s37, s28, 5
    s_add_u32 s37, s37, s29
    s_mul_i32 s48, s37, 73728
    s_and_b32 s37, s30, 2
    s_lshl_b32 s37, s37, 11
    s_add_u32 s48, s48, s37
    s_and_b32 s37, s30, 1
    s_lshl_b32 s37, s37, 10
    s_add_u32 s48, s48, s37
    s_add_u32 s48, s48, 18874368
    s_add_u32 s33, s48, 65536
    s_mul_i32 s50, s29, 1152
    s_add_u32 s50, s50, 327680
    s_mov_b32 s51, s28
    v_add_u32 v234, s28, v3
    v_and_b32 v234, 7, v234
    v_lshlrev_b32 v234, 7, v234
    v_lshl_add_u32 v234, v3, 2, v234
    s_lshl_b32 s52, s28, 2
    s_add_u32 s52, s52, 1024
    v_cmp_eq_u32 vcc, 0, v3
    v_mov_b32 v232, s52
    v_mov_b32 v233, 0x40000000
    v_cndmask_b32 v234, v234, v232, vcc
    v_cmp_gt_u32 vcc, 6, v3
    s_nop 1
    v_cndmask_b32 v232, v233, v234, vcc
    v_cndmask_b32 v234, v234, v233, vcc
    v_cmp_gt_u32 vcc, 8, v3
    s_nop 1
    v_cndmask_b32 v234, v233, v234, vcc
    v_mov_b32 v233, 1
    s_lshl_b32 s44, s37, 1
    s_lshr_b32 s37, s36, 1
    s_lshl_b32 s37, s37, 12
    s_and_b32 s40, s36, 1
    s_lshl_b32 s40, s40, 3
    s_add_u32 s42, s37, s40
    s_add_u32 s36, s36, 1
    s_lshr_b32 s37, s36, 1
    s_lshl_b32 s37, s37, 12
    s_and_b32 s40, s36, 1
    s_lshl_b32 s40, s40, 3
    s_add_u32 s43, s37, s40
    v_mov_b32 v88, 0
    v_mov_b32 v89, 0
    v_mov_b32 v90, 0
    v_mov_b32 v91, 0
    v_mov_b32 v92, 0
    v_mov_b32 v93, 0
    v_mov_b32 v94, 0
    v_mov_b32 v95, 0
    v_mov_b32 v96, 0
    v_mov_b32 v97, 0
    v_mov_b32 v98, 0
    v_mov_b32 v99, 0
    v_mov_b32 v100, 0
    v_mov_b32 v101, 0
    v_mov_b32 v102, 0
    v_mov_b32 v103, 0
    v_mov_b32 v104, 0
    v_mov_b32 v105, 0
    v_mov_b32 v106, 0
    v_mov_b32 v107, 0
    v_mov_b32 v108, 0
    v_mov_b32 v109, 0
    v_mov_b32 v110, 0
    v_mov_b32 v111, 0
    v_mov_b32 v112, 0
    v_mov_b32 v113, 0
    v_mov_b32 v114, 0
    v_mov_b32 v115, 0
    v_mov_b32 v116, 0
    v_mov_b32 v117, 0
    v_mov_b32 v118, 0
    v_mov_b32 v119, 0
    v_mov_b32 v120, 0
    v_mov_b32 v121, 0
    v_mov_b32 v122, 0
    v_mov_b32 v123, 0
    v_mov_b32 v124, 0
    v_mov_b32 v125, 0
    v_mov_b32 v126, 0
    v_mov_b32 v127, 0
    v_mov_b32 v128, 0
    v_mov_b32 v129, 0
    v_mov_b32 v130, 0
    v_mov_b32 v131, 0
    v_mov_b32 v132, 0
    v_mov_b32 v133, 0
    v_mov_b32 v134, 0
    v_mov_b32 v135, 0
    v_mov_b32 v136, 0
    v_mov_b32 v137, 0
    v_mov_b32 v138, 0
    v_mov_b32 v139, 0
    v_mov_b32 v140, 0
    v_mov_b32 v141, 0
    v_mov_b32 v142, 0
    v_mov_b32 v143, 0
    v_mov_b32 v144, 0
    v_mov_b32 v145, 0
    v_mov_b32 v146, 0
    v_mov_b32 v147, 0
    v_mov_b32 v148, 0
    v_mov_b32 v149, 0
    v_mov_b32 v150, 0
    v_mov_b32 v151, 0
    v_mov_b32 v152, 0
    v_mov_b32 v153, 0
    v_mov_b32 v154, 0
    v_mov_b32 v155, 0
    v_mov_b32 v156, 0
    v_mov_b32 v157, 0
    v_mov_b32 v158, 0
    v_mov_b32 v159, 0
    v_mov_b32 v160, 0
    v_mov_b32 v161, 0
    v_mov_b32 v162, 0
    v_mov_b32 v163, 0
    v_mov_b32 v164, 0
    v_mov_b32 v165, 0
    v_mov_b32 v166, 0
    v_mov_b32 v167, 0
    v_mov_b32 v168, 0
    v_mov_b32 v169, 0
    v_mov_b32 v170, 0
    v_mov_b32 v171, 0
    v_mov_b32 v172, 0
    v_mov_b32 v173, 0
    v_mov_b32 v174, 0
    v_mov_b32 v175, 0
    v_mov_b32 v176, 0
    v_mov_b32 v177, 0
    v_mov_b32 v178, 0
    v_mov_b32 v179, 0
    v_mov_b32 v180, 0
    v_mov_b32 v181, 0
    v_mov_b32 v182, 0
    v_mov_b32 v183, 0
    v_mov_b32 v184, 0
    v_mov_b32 v185, 0
    v_mov_b32 v186, 0
    v_mov_b32 v187, 0
    v_mov_b32 v188, 0
    v_mov_b32 v189, 0
    v_mov_b32 v190, 0
    v_mov_b32 v191, 0
    v_mov_b32 v192, 0
    v_mov_b32 v193, 0
    v_mov_b32 v194, 0
    v_mov_b32 v195, 0
    v_mov_b32 v196, 0
    v_mov_b32 v197, 0
    v_mov_b32 v198, 0
    v_mov_b32 v199, 0
    v_mov_b32 v200, 0
    v_mov_b32 v201, 0
    v_mov_b32 v202, 0
    v_mov_b32 v203, 0
    v_mov_b32 v204, 0
    v_mov_b32 v205, 0
    v_mov_b32 v206, 0
    v_mov_b32 v207, 0
    v_mov_b32 v208, 0
    v_mov_b32 v209, 0
    v_mov_b32 v210, 0
    v_mov_b32 v211, 0
    v_mov_b32 v212, 0
    v_mov_b32 v213, 0
    v_mov_b32 v214, 0
    v_mov_b32 v215, 0
    v_mov_b32 v216, 0
    v_mov_b32 v217, 0
    v_mov_b32 v218, 0
    v_mov_b32 v219, 0
    v_mov_b32 v220, 0
    v_mov_b32 v221, 0
    v_mov_b32 v222, 0
    v_mov_b32 v223, 0
    v_mov_b32 v224, 0
    v_mov_b32 v225, 0
    v_mov_b32 v226, 0
    v_mov_b32 v227, 0
    v_mov_b32 v228, 0
    v_mov_b32 v229, 0
    v_mov_b32 v230, 0
    v_mov_b32 v231, 0
    s_mov_b32 s46, 0
    s_mov_b32 s47, 73728
    s_waitcnt lgkmcnt(0)
    s_barrier
    ds_read_b64_tr_b16 v[12:13], v5 offset:0
    ds_read_b64_tr_b16 v[14:15], v5 offset:18432
    ds_read_b128 v[48:51], v11 offset:0
    ds_read_b128 v[52:55], v11 offset:1024
    ds_read_b64_tr_b16 v[16:17], v6 offset:0
    ds_read_b64_tr_b16 v[18:19], v6 offset:18432
    ds_read_b128 v[56:59], v11 offset:2048
    ds_read_b128 v[60:63], v11 offset:3072
    ds_read_b64_tr_b16 v[20:21], v7 offset:0
    ds_read_b64_tr_b16 v[22:23], v7 offset:18432
    ds_read_b64_tr_b16 v[24:25], v8 offset:0
    ds_read_b64_tr_b16 v[26:27], v8 offset:18432
    ds_read_b64_tr_b16 v[28:29], v5 offset:128
    ds_read_b64_tr_b16 v[30:31], v5 offset:18560
    .p2align 6
k4_l1_35:
    s_waitcnt lgkmcnt(12)
    s_waitcnt lgkmcnt(6)
    v_mfma_f32_16x16x32_bf16 v[88:91], v[12:15], v[48:51], v[88:91]
    ds_read_b64_tr_b16 v[32:33], v6 offset:128
    v_mfma_f32_16x16x32_bf16 v[92:95], v[12:15], v[52:55], v[92:95]
    ds_read_b64_tr_b16 v[34:35], v6 offset:18560
    v_mfma_f32_16x16x32_bf16 v[96:99], v[12:15], v[56:59], v[96:99]
    v_mfma_f32_16x16x32_bf16 v[100:103], v[12:15], v[60:63], v[100:103]
    v_mfma_f32_16x16x32_bf16 v[104:107], v[16:19], v[48:51], v[104:107]
    ds_read_b64_tr_b16 v[36:37], v7 offset:128
    v_mfma_f32_16x16x32_bf16 v[108:111], v[16:19], v[52:55], v[108:111]
    ds_read_b64_tr_b16 v[38:39], v7 offset:18560
    v_mfma_f32_16x16x32_bf16 v[112:115], v[16:19], v[56:59], v[112:115]
    v_mfma_f32_16x16x32_bf16 v[116:119], v[16:19], v[60:63], v[116:119]
    s_waitcnt lgkmcnt(8)
    v_mfma_f32_16x16x32_bf16 v[120:123], v[20:23], v[48:51], v[120:123]
    ds_read_b64_tr_b16 v[40:41], v8 offset:128
    v_mfma_f32_16x16x32_bf16 v[124:127], v[20:23], v[52:55], v[124:127]
    ds_read_b64_tr_b16 v[42:43], v8 offset:18560
    v_mfma_f32_16x16x32_bf16 v[128:131], v[20:23], v[56:59], v[128:131]
    v_mfma_f32_16x16x32_bf16 v[132:135], v[20:23], v[60:63], v[132:135]
    s_waitcnt lgkmcnt(8)
    v_mfma_f32_16x16x32_bf16 v[136:139], v[24:27], v[48:51], v[136:139]
    ds_read_b64_tr_b16 v[44:45], v5 offset:256
    v_mfma_f32_16x16x32_bf16 v[140:143], v[24:27], v[52:55], v[140:143]
    ds_read_b64_tr_b16 v[46:47], v5 offset:18688
    v_mfma_f32_16x16x32_bf16 v[144:147], v[24:27], v[56:59], v[144:147]
    v_mfma_f32_16x16x32_bf16 v[148:151], v[24:27], v[60:63], v[148:151]
    s_waitcnt lgkmcnt(8)
    v_mfma_f32_16x16x32_bf16 v[152:155], v[28:31], v[48:51], v[152:155]
    v_mfma_f32_16x16x32_bf16 v[156:159], v[28:31], v[52:55], v[156:159]
    v_mfma_f32_16x16x32_bf16 v[160:163], v[28:31], v[56:59], v[160:163]
    v_mfma_f32_16x16x32_bf16 v[164:167], v[28:31], v[60:63], v[164:167]
    s_waitcnt lgkmcnt(0)
    s_barrier
    v_mfma_f32_16x16x32_bf16 v[168:171], v[32:35], v[48:51], v[168:171]
    ds_read_b64_tr_b16 v[12:13], v5 offset:36864
    v_mfma_f32_16x16x32_bf16 v[172:175], v[32:35], v[52:55], v[172:175]
    ds_read_b64_tr_b16 v[14:15], v5 offset:55296
    v_mfma_f32_16x16x32_bf16 v[176:179], v[32:35], v[56:59], v[176:179]
    ds_read_b128 v[64:67], v11 offset:4096
    v_mfma_f32_16x16x32_bf16 v[180:183], v[32:35], v[60:63], v[180:183]
    ds_read_b128 v[68:71], v11 offset:5120
    v_mfma_f32_16x16x32_bf16 v[184:187], v[36:39], v[48:51], v[184:187]
    ds_read_b64_tr_b16 v[16:17], v6 offset:36864
    v_mfma_f32_16x16x32_bf16 v[188:191], v[36:39], v[52:55], v[188:191]
    ds_read_b64_tr_b16 v[18:19], v6 offset:55296
    v_mfma_f32_16x16x32_bf16 v[192:195], v[36:39], v[56:59], v[192:195]
    ds_read_b128 v[72:75], v11 offset:6144
    v_mfma_f32_16x16x32_bf16 v[196:199], v[36:39], v[60:63], v[196:199]
    ds_read_b128 v[76:79], v11 offset:7168
    v_mfma_f32_16x16x32_bf16 v[200:203], v[40:43], v[48:51], v[200:203]
    ds_read_b64_tr_b16 v[20:21], v7 offset:36864
    v_mfma_f32_16x16x32_bf16 v[204:207], v[40:43], v[52:55], v[204:207]
    ds_read_b64_tr_b16 v[22:23], v7 offset:55296
    v_mfma_f32_16x16x32_bf16 v[208:211], v[40:43], v[56:59], v[208:211]
    ds_read_b64_tr_b16 v[24:25], v8 offset:36864
    v_mfma_f32_16x16x32_bf16 v[212:215], v[40:43], v[60:63], v[212:215]
    ds_read_b64_tr_b16 v[26:27], v8 offset:55296
    v_mfma_f32_16x16x32_bf16 v[216:219], v[44:47], v[48:51], v[216:219]
    ds_read_b64_tr_b16 v[28:29], v5 offset:36992
    v_mfma_f32_16x16x32_bf16 v[220:223], v[44:47], v[52:55], v[220:223]
    ds_read_b64_tr_b16 v[30:31], v5 offset:55424
    v_mfma_f32_16x16x32_bf16 v[224:227], v[44:47], v[56:59], v[224:227]
    v_mfma_f32_16x16x32_bf16 v[228:231], v[44:47], v[60:63], v[228:231]
    s_waitcnt lgkmcnt(12)
    s_waitcnt lgkmcnt(6)
    v_mfma_f32_16x16x32_bf16 v[88:91], v[12:15], v[64:67], v[88:91]
    ds_read_b64_tr_b16 v[32:33], v6 offset:36992
    v_mfma_f32_16x16x32_bf16 v[92:95], v[12:15], v[68:71], v[92:95]
    ds_read_b64_tr_b16 v[34:35], v6 offset:55424
    v_mfma_f32_16x16x32_bf16 v[96:99], v[12:15], v[72:75], v[96:99]
    v_mfma_f32_16x16x32_bf16 v[100:103], v[12:15], v[76:79], v[100:103]
    v_mfma_f32_16x16x32_bf16 v[104:107], v[16:19], v[64:67], v[104:107]
    ds_read_b64_tr_b16 v[36:37], v7 offset:36992
    v_mfma_f32_16x16x32_bf16 v[108:111], v[16:19], v[68:71], v[108:111]
    ds_read_b64_tr_b16 v[38:39], v7 offset:55424
    v_mfma_f32_16x16x32_bf16 v[112:115], v[16:19], v[72:75], v[112:115]
    v_mfma_f32_16x16x32_bf16 v[116:119], v[16:19], v[76:79], v[116:119]
    s_waitcnt lgkmcnt(8)
    v_mfma_f32_16x16x32_bf16 v[120:123], v[20:23], v[64:67], v[120:123]
    ds_read_b64_tr_b16 v[40:41], v8 offset:36992
    v_mfma_f32_16x16x32_bf16 v[124:127], v[20:23], v[68:71], v[124:127]
    ds_read_b64_tr_b16 v[42:43], v8 offset:55424
    v_mfma_f32_16x16x32_bf16 v[128:131], v[20:23], v[72:75], v[128:131]
    v_mfma_f32_16x16x32_bf16 v[132:135], v[20:23], v[76:79], v[132:135]
    s_waitcnt lgkmcnt(8)
    v_mfma_f32_16x16x32_bf16 v[136:139], v[24:27], v[64:67], v[136:139]
    ds_read_b64_tr_b16 v[44:45], v5 offset:37120
    v_mfma_f32_16x16x32_bf16 v[140:143], v[24:27], v[68:71], v[140:143]
    ds_read_b64_tr_b16 v[46:47], v5 offset:55552
    v_mfma_f32_16x16x32_bf16 v[144:147], v[24:27], v[72:75], v[144:147]
    v_mfma_f32_16x16x32_bf16 v[148:151], v[24:27], v[76:79], v[148:151]
    v_add_u32 v5, s47, v5
    s_waitcnt lgkmcnt(8)
    v_mfma_f32_16x16x32_bf16 v[152:155], v[28:31], v[64:67], v[152:155]
    v_add_u32 v6, s47, v6
    v_mfma_f32_16x16x32_bf16 v[156:159], v[28:31], v[68:71], v[156:159]
    v_add_u32 v7, s47, v7
    v_mfma_f32_16x16x32_bf16 v[160:163], v[28:31], v[72:75], v[160:163]
    v_add_u32 v8, s47, v8
    v_mfma_f32_16x16x32_bf16 v[164:167], v[28:31], v[76:79], v[164:167]
    s_waitcnt lgkmcnt(0)
    s_barrier
    v_mfma_f32_16x16x32_bf16 v[168:171], v[32:35], v[64:67], v[168:171]
    ds_read_b64_tr_b16 v[12:13], v5 offset:0
    v_mfma_f32_16x16x32_bf16 v[172:175], v[32:35], v[68:71], v[172:175]
    ds_read_b64_tr_b16 v[14:15], v5 offset:18432
    v_mfma_f32_16x16x32_bf16 v[176:179], v[32:35], v[72:75], v[176:179]
    ds_read_b128 v[48:51], v11 offset:0
    v_mfma_f32_16x16x32_bf16 v[180:183], v[32:35], v[76:79], v[180:183]
    ds_read_b128 v[52:55], v11 offset:1024
    v_mfma_f32_16x16x32_bf16 v[184:187], v[36:39], v[64:67], v[184:187]
    ds_read_b64_tr_b16 v[16:17], v6 offset:0
    v_mfma_f32_16x16x32_bf16 v[188:191], v[36:39], v[68:71], v[188:191]
    ds_read_b64_tr_b16 v[18:19], v6 offset:18432
    v_mfma_f32_16x16x32_bf16 v[192:195], v[36:39], v[72:75], v[192:195]
    ds_read_b128 v[56:59], v11 offset:2048
    v_mfma_f32_16x16x32_bf16 v[196:199], v[36:39], v[76:79], v[196:199]
    ds_read_b128 v[60:63], v11 offset:3072
    v_mfma_f32_16x16x32_bf16 v[200:203], v[40:43], v[64:67], v[200:203]
    ds_read_b64_tr_b16 v[20:21], v7 offset:0
    v_mfma_f32_16x16x32_bf16 v[204:207], v[40:43], v[68:71], v[204:207]
    ds_read_b64_tr_b16 v[22:23], v7 offset:18432
    v_mfma_f32_16x16x32_bf16 v[208:211], v[40:43], v[72:75], v[208:211]
    ds_read_b64_tr_b16 v[24:25], v8 offset:0
    v_mfma_f32_16x16x32_bf16 v[212:215], v[40:43], v[76:79], v[212:215]
    ds_read_b64_tr_b16 v[26:27], v8 offset:18432
    v_mfma_f32_16x16x32_bf16 v[216:219], v[44:47], v[64:67], v[216:219]
    ds_read_b64_tr_b16 v[28:29], v5 offset:128
    v_mfma_f32_16x16x32_bf16 v[220:223], v[44:47], v[68:71], v[220:223]
    ds_read_b64_tr_b16 v[30:31], v5 offset:18560
    v_mfma_f32_16x16x32_bf16 v[224:227], v[44:47], v[72:75], v[224:227]
    s_sub_u32 s47, 0, s47
    s_add_u32 s46, s46, 1
    v_mfma_f32_16x16x32_bf16 v[228:231], v[44:47], v[76:79], v[228:231]
    s_cmp_lt_u32 s46, 8
    s_cbranch_scc1 k4_l1_35
    s_waitcnt lgkmcnt(12)
    s_waitcnt lgkmcnt(6)
    v_mfma_f32_16x16x32_bf16 v[88:91], v[12:15], v[48:51], v[88:91]
    ds_read_b64_tr_b16 v[32:33], v6 offset:128
    v_mfma_f32_16x16x32_bf16 v[92:95], v[12:15], v[52:55], v[92:95]
    ds_read_b64_tr_b16 v[34:35], v6 offset:18560
    v_mfma_f32_16x16x32_bf16 v[96:99], v[12:15], v[56:59], v[96:99]
    v_mfma_f32_16x16x32_bf16 v[100:103], v[12:15], v[60:63], v[100:103]
    v_mfma_f32_16x16x32_bf16 v[104:107], v[16:19], v[48:51], v[104:107]
    ds_read_b64_tr_b16 v[36:37], v7 offset:128
    v_mfma_f32_16x16x32_bf16 v[108:111], v[16:19], v[52:55], v[108:111]
    ds_read_b64_tr_b16 v[38:39], v7 offset:18560
    v_mfma_f32_16x16x32_bf16 v[112:115], v[16:19], v[56:59], v[112:115]
    v_mfma_f32_16x16x32_bf16 v[116:119], v[16:19], v[60:63], v[116:119]
    s_waitcnt lgkmcnt(8)
    v_mfma_f32_16x16x32_bf16 v[120:123], v[20:23], v[48:51], v[120:123]
    ds_read_b64_tr_b16 v[40:41], v8 offset:128
    v_mfma_f32_16x16x32_bf16 v[124:127], v[20:23], v[52:55], v[124:127]
    ds_read_b64_tr_b16 v[42:43], v8 offset:18560
    v_mfma_f32_16x16x32_bf16 v[128:131], v[20:23], v[56:59], v[128:131]
    v_mfma_f32_16x16x32_bf16 v[132:135], v[20:23], v[60:63], v[132:135]
    s_waitcnt lgkmcnt(8)
    v_mfma_f32_16x16x32_bf16 v[136:139], v[24:27], v[48:51], v[136:139]
    ds_read_b64_tr_b16 v[44:45], v5 offset:256
    v_mfma_f32_16x16x32_bf16 v[140:143], v[24:27], v[52:55], v[140:143]
    ds_read_b64_tr_b16 v[46:47], v5 offset:18688
    v_mfma_f32_16x16x32_bf16 v[144:147], v[24:27], v[56:59], v[144:147]
    v_mfma_f32_16x16x32_bf16 v[148:151], v[24:27], v[60:63], v[148:151]
    s_waitcnt lgkmcnt(8)
    v_mfma_f32_16x16x32_bf16 v[152:155], v[28:31], v[48:51], v[152:155]
    v_mfma_f32_16x16x32_bf16 v[156:159], v[28:31], v[52:55], v[156:159]
    v_mfma_f32_16x16x32_bf16 v[160:163], v[28:31], v[56:59], v[160:163]
    v_mfma_f32_16x16x32_bf16 v[164:167], v[28:31], v[60:63], v[164:167]
    s_waitcnt lgkmcnt(0)
    s_barrier
    v_mfma_f32_16x16x32_bf16 v[168:171], v[32:35], v[48:51], v[168:171]
    ds_read_b64_tr_b16 v[12:13], v5 offset:36864
    v_mfma_f32_16x16x32_bf16 v[172:175], v[32:35], v[52:55], v[172:175]
    ds_read_b64_tr_b16 v[14:15], v5 offset:55296
    v_mfma_f32_16x16x32_bf16 v[176:179], v[32:35], v[56:59], v[176:179]
    ds_read_b128 v[64:67], v11 offset:4096
    v_mfma_f32_16x16x32_bf16 v[180:183], v[32:35], v[60:63], v[180:183]
    ds_read_b128 v[68:71], v11 offset:5120
    v_mfma_f32_16x16x32_bf16 v[184:187], v[36:39], v[48:51], v[184:187]
    ds_read_b64_tr_b16 v[16:17], v6 offset:36864
    v_mfma_f32_16x16x32_bf16 v[188:191], v[36:39], v[52:55], v[188:191]
    ds_read_b64_tr_b16 v[18:19], v6 offset:55296
    v_mfma_f32_16x16x32_bf16 v[192:195], v[36:39], v[56:59], v[192:195]
    ds_read_b128 v[72:75], v11 offset:6144
    v_mfma_f32_16x16x32_bf16 v[196:199], v[36:39], v[60:63], v[196:199]
    ds_read_b128 v[76:79], v11 offset:7168
    v_mfma_f32_16x16x32_bf16 v[200:203], v[40:43], v[48:51], v[200:203]
    ds_read_b64_tr_b16 v[20:21], v7 offset:36864
    v_mfma_f32_16x16x32_bf16 v[204:207], v[40:43], v[52:55], v[204:207]
    ds_read_b64_tr_b16 v[22:23], v7 offset:55296
    v_mfma_f32_16x16x32_bf16 v[208:211], v[40:43], v[56:59], v[208:211]
    ds_read_b64_tr_b16 v[24:25], v8 offset:36864
    v_mfma_f32_16x16x32_bf16 v[212:215], v[40:43], v[60:63], v[212:215]
    ds_read_b64_tr_b16 v[26:27], v8 offset:55296
    v_mfma_f32_16x16x32_bf16 v[216:219], v[44:47], v[48:51], v[216:219]
    ds_read_b64_tr_b16 v[28:29], v5 offset:36992
    v_mfma_f32_16x16x32_bf16 v[220:223], v[44:47], v[52:55], v[220:223]
    ds_read_b64_tr_b16 v[30:31], v5 offset:55424
    v_mfma_f32_16x16x32_bf16 v[224:227], v[44:47], v[56:59], v[224:227]
    v_mfma_f32_16x16x32_bf16 v[228:231], v[44:47], v[60:63], v[228:231]
    s_waitcnt lgkmcnt(12)
    s_waitcnt lgkmcnt(6)
    v_mfma_f32_16x16x32_bf16 v[88:91], v[12:15], v[64:67], v[88:91]
    ds_read_b64_tr_b16 v[32:33], v6 offset:36992
    v_mfma_f32_16x16x32_bf16 v[92:95], v[12:15], v[68:71], v[92:95]
    ds_read_b64_tr_b16 v[34:35], v6 offset:55424
    v_mfma_f32_16x16x32_bf16 v[96:99], v[12:15], v[72:75], v[96:99]
    v_mfma_f32_16x16x32_bf16 v[100:103], v[12:15], v[76:79], v[100:103]
    v_mfma_f32_16x16x32_bf16 v[104:107], v[16:19], v[64:67], v[104:107]
    ds_read_b64_tr_b16 v[36:37], v7 offset:36992
    v_mfma_f32_16x16x32_bf16 v[108:111], v[16:19], v[68:71], v[108:111]
    ds_read_b64_tr_b16 v[38:39], v7 offset:55424
    v_mfma_f32_16x16x32_bf16 v[112:115], v[16:19], v[72:75], v[112:115]
    v_mfma_f32_16x16x32_bf16 v[116:119], v[16:19], v[76:79], v[116:119]
    s_waitcnt lgkmcnt(8)
    v_mfma_f32_16x16x32_bf16 v[120:123], v[20:23], v[64:67], v[120:123]
    ds_read_b64_tr_b16 v[40:41], v8 offset:36992
    v_mfma_f32_16x16x32_bf16 v[124:127], v[20:23], v[68:71], v[124:127]
    ds_read_b64_tr_b16 v[42:43], v8 offset:55424
    v_mfma_f32_16x16x32_bf16 v[128:131], v[20:23], v[72:75], v[128:131]
    v_mfma_f32_16x16x32_bf16 v[132:135], v[20:23], v[76:79], v[132:135]
    s_waitcnt lgkmcnt(8)
    v_mfma_f32_16x16x32_bf16 v[136:139], v[24:27], v[64:67], v[136:139]
    ds_read_b64_tr_b16 v[44:45], v5 offset:37120
    v_cvt_pk_bf16_f32 v88, v88, v89
    v_cvt_pk_bf16_f32 v89, v90, v91
    v_pk_max_i16 v88, v88, 0
    v_pk_max_i16 v89, v89, 0
    v_mfma_f32_16x16x32_bf16 v[140:143], v[24:27], v[68:71], v[140:143]
    ds_read_b64_tr_b16 v[46:47], v5 offset:55552
    v_cvt_pk_bf16_f32 v92, v92, v93
    v_cvt_pk_bf16_f32 v93, v94, v95
    v_pk_max_i16 v92, v92, 0
    v_pk_max_i16 v93, v93, 0
    v_mfma_f32_16x16x32_bf16 v[144:147], v[24:27], v[72:75], v[144:147]
    v_cvt_pk_bf16_f32 v96, v96, v97
    v_cvt_pk_bf16_f32 v97, v98, v99
    v_pk_max_i16 v96, v96, 0
    v_pk_max_i16 v97, v97, 0
    v_add_u32 v2, s42, v1
    v_mfma_f32_16x16x32_bf16 v[148:151], v[24:27], v[76:79], v[148:151]
    v_cvt_pk_bf16_f32 v100, v100, v101
    v_cvt_pk_bf16_f32 v101, v102, v103
    v_pk_max_i16 v100, v100, 0
    v_pk_max_i16 v101, v101, 0
    v_add_u32 v4, s43, v1
    s_waitcnt lgkmcnt(8)
    v_mfma_f32_16x16x32_bf16 v[152:155], v[28:31], v[64:67], v[152:155]
    v_cvt_pk_bf16_f32 v104, v104, v105
    v_cvt_pk_bf16_f32 v105, v106, v107
    v_pk_max_i16 v104, v104, 0
    v_pk_max_i16 v105, v105, 0
    v_mfma_f32_16x16x32_bf16 v[156:159], v[28:31], v[68:71], v[156:159]
    v_cvt_pk_bf16_f32 v108, v108, v109
    v_cvt_pk_bf16_f32 v109, v110, v111
    v_pk_max_i16 v108, v108, 0
    v_pk_max_i16 v109, v109, 0
    v_mfma_f32_16x16x32_bf16 v[160:163], v[28:31], v[72:75], v[160:163]
    v_cvt_pk_bf16_f32 v112, v112, v113
    v_cvt_pk_bf16_f32 v113, v114, v115
    v_pk_max_i16 v112, v112, 0
    v_pk_max_i16 v113, v113, 0
    v_mfma_f32_16x16x32_bf16 v[164:167], v[28:31], v[76:79], v[164:167]
    s_waitcnt lgkmcnt(0)
    s_barrier
    v_cvt_pk_bf16_f32 v116, v116, v117
    v_cvt_pk_bf16_f32 v117, v118, v119
    v_pk_max_i16 v116, v116, 0
    v_pk_max_i16 v117, v117, 0
    v_mfma_f32_16x16x32_bf16 v[168:171], v[32:35], v[64:67], v[168:171]
    ds_read_b64_tr_b16 v[12:13], v9 offset:0
    v_cvt_pk_bf16_f32 v120, v120, v121
    v_cvt_pk_bf16_f32 v121, v122, v123
    v_pk_max_i16 v120, v120, 0
    v_pk_max_i16 v121, v121, 0
    ds_write_b64 v2, v[88:89] offset:0
    v_mfma_f32_16x16x32_bf16 v[172:175], v[32:35], v[68:71], v[172:175]
    ds_read_b64_tr_b16 v[14:15], v9 offset:2048
    v_cvt_pk_bf16_f32 v124, v124, v125
    v_cvt_pk_bf16_f32 v125, v126, v127
    v_pk_max_i16 v124, v124, 0
    v_pk_max_i16 v125, v125, 0
    ds_write_b64 v2, v[92:93] offset:1024
    v_mfma_f32_16x16x32_bf16 v[176:179], v[32:35], v[72:75], v[176:179]
    ds_read_b64_tr_b16 v[16:17], v10 offset:0
    v_cvt_pk_bf16_f32 v128, v128, v129
    v_cvt_pk_bf16_f32 v129, v130, v131
    v_pk_max_i16 v128, v128, 0
    v_pk_max_i16 v129, v129, 0
    ds_write_b64 v2, v[96:97] offset:2048
    v_mfma_f32_16x16x32_bf16 v[180:183], v[32:35], v[76:79], v[180:183]
    ds_read_b64_tr_b16 v[18:19], v10 offset:2048
    v_cvt_pk_bf16_f32 v132, v132, v133
    v_cvt_pk_bf16_f32 v133, v134, v135
    v_pk_max_i16 v132, v132, 0
    v_pk_max_i16 v133, v133, 0
    ds_write_b64 v2, v[100:101] offset:3072
    v_mfma_f32_16x16x32_bf16 v[184:187], v[36:39], v[64:67], v[184:187]
    ds_read_b64_tr_b16 v[20:21], v9 offset:4096
    v_cvt_pk_bf16_f32 v136, v136, v137
    v_cvt_pk_bf16_f32 v137, v138, v139
    v_pk_max_i16 v136, v136, 0
    v_pk_max_i16 v137, v137, 0
    ds_write_b64 v4, v[104:105] offset:0
    v_mfma_f32_16x16x32_bf16 v[188:191], v[36:39], v[68:71], v[188:191]
    ds_read_b64_tr_b16 v[22:23], v9 offset:6144
    v_cvt_pk_bf16_f32 v140, v140, v141
    v_cvt_pk_bf16_f32 v141, v142, v143
    v_pk_max_i16 v140, v140, 0
    v_pk_max_i16 v141, v141, 0
    ds_write_b64 v4, v[108:109] offset:1024
    v_mfma_f32_16x16x32_bf16 v[192:195], v[36:39], v[72:75], v[192:195]
    ds_read_b64_tr_b16 v[24:25], v10 offset:4096
    v_cvt_pk_bf16_f32 v144, v144, v145
    v_cvt_pk_bf16_f32 v145, v146, v147
    v_pk_max_i16 v144, v144, 0
    v_pk_max_i16 v145, v145, 0
    ds_write_b64 v4, v[112:113] offset:2048
    v_mfma_f32_16x16x32_bf16 v[196:199], v[36:39], v[76:79], v[196:199]
    ds_read_b64_tr_b16 v[26:27], v10 offset:6144
    v_cvt_pk_bf16_f32 v148, v148, v149
    v_cvt_pk_bf16_f32 v149, v150, v151
    v_pk_max_i16 v148, v148, 0
    v_pk_max_i16 v149, v149, 0
    s_waitcnt lgkmcnt(8)
    ds_write_b64 v4, v[116:117] offset:3072
    v_mfma_f32_16x16x32_bf16 v[200:203], v[40:43], v[64:67], v[200:203]
    ds_read_b64_tr_b16 v[28:29], v9 offset:8192
    v_cvt_pk_bf16_f32 v152, v152, v153
    v_cvt_pk_bf16_f32 v153, v154, v155
    v_pk_max_i16 v152, v152, 0
    v_pk_max_i16 v153, v153, 0
    ds_write_b64 v2, v[120:121] offset:4096
    v_mfma_f32_16x16x32_bf16 v[204:207], v[40:43], v[68:71], v[204:207]
    ds_read_b64_tr_b16 v[30:31], v9 offset:10240
    v_cvt_pk_bf16_f32 v156, v156, v157
    v_cvt_pk_bf16_f32 v157, v158, v159
    v_pk_max_i16 v156, v156, 0
    v_pk_max_i16 v157, v157, 0
    ds_write_b64 v2, v[124:125] offset:5120
    v_mfma_f32_16x16x32_bf16 v[208:211], v[40:43], v[72:75], v[208:211]
    ds_read_b64_tr_b16 v[32:33], v10 offset:8192
    v_cvt_pk_bf16_f32 v160, v160, v161
    v_cvt_pk_bf16_f32 v161, v162, v163
    v_pk_max_i16 v160, v160, 0
    v_pk_max_i16 v161, v161, 0
    ds_write_b64 v2, v[128:129] offset:6144
    v_mfma_f32_16x16x32_bf16 v[212:215], v[40:43], v[76:79], v[212:215]
    s_waitcnt lgkmcnt(14)
    ds_read_b64_tr_b16 v[34:35], v10 offset:10240
    v_cvt_pk_bf16_f32 v164, v164, v165
    v_cvt_pk_bf16_f32 v165, v166, v167
    v_pk_max_i16 v164, v164, 0
    v_pk_max_i16 v165, v165, 0
    s_waitcnt lgkmcnt(8)
    ds_write_b64 v2, v[132:133] offset:7168
    v_mfma_f32_16x16x32_bf16 v[216:219], v[44:47], v[64:67], v[216:219]
    v_cvt_pk_bf16_f32 v168, v168, v169
    v_cvt_pk_bf16_f32 v169, v170, v171
    v_pk_max_i16 v168, v168, 0
    v_pk_max_i16 v169, v169, 0
    ds_write_b64 v4, v[136:137] offset:4096
    v_mfma_f32_16x16x32_bf16 v[220:223], v[44:47], v[68:71], v[220:223]
    ds_read_b64_tr_b16 v[36:37], v9 offset:12288
    v_cvt_pk_bf16_f32 v172, v172, v173
    v_cvt_pk_bf16_f32 v173, v174, v175
    v_pk_max_i16 v172, v172, 0
    v_pk_max_i16 v173, v173, 0
    ds_write_b64 v4, v[140:141] offset:5120
    v_mfma_f32_16x16x32_bf16 v[224:227], v[44:47], v[72:75], v[224:227]
    ds_read_b64_tr_b16 v[38:39], v9 offset:14336
    v_cvt_pk_bf16_f32 v176, v176, v177
    v_cvt_pk_bf16_f32 v177, v178, v179
    v_pk_max_i16 v176, v176, 0
    v_pk_max_i16 v177, v177, 0
    ds_write_b64 v4, v[144:145] offset:6144
    v_mfma_f32_16x16x32_bf16 v[228:231], v[44:47], v[76:79], v[228:231]
    v_cvt_pk_bf16_f32 v180, v180, v181
    v_cvt_pk_bf16_f32 v181, v182, v183
    v_pk_max_i16 v180, v180, 0
    v_pk_max_i16 v181, v181, 0
    ds_write_b64 v4, v[148:149] offset:7168
    s_waitcnt lgkmcnt(8)
    ds_write_b64 v2, v[152:153] offset:8192
    ds_write_b64 v2, v[156:157] offset:9216
    ds_write_b64 v2, v[160:161] offset:10240
    ds_write_b64 v2, v[164:165] offset:11264
    ds_write_b64 v4, v[168:169] offset:8192
    ds_write_b64 v4, v[172:173] offset:9216
    ds_write_b64 v4, v[176:177] offset:10240
    s_waitcnt lgkmcnt(8)
    ds_write_b64 v4, v[180:181] offset:11264
    v_cvt_pk_bf16_f32 v184, v184, v185
    v_cvt_pk_bf16_f32 v185, v186, v187
    v_pk_max_i16 v184, v184, 0
    v_pk_max_i16 v185, v185, 0
    v_cvt_pk_bf16_f32 v188, v188, v189
    v_cvt_pk_bf16_f32 v189, v190, v191
    v_pk_max_i16 v188, v188, 0
    v_pk_max_i16 v189, v189, 0
    v_cvt_pk_bf16_f32 v192, v192, v193
    v_cvt_pk_bf16_f32 v193, v194, v195
    v_pk_max_i16 v192, v192, 0
    v_pk_max_i16 v193, v193, 0
    v_cvt_pk_bf16_f32 v196, v196, v197
    v_cvt_pk_bf16_f32 v197, v198, v199
    v_pk_max_i16 v196, v196, 0
    v_pk_max_i16 v197, v197, 0
    ds_write_b64 v2, v[184:185] offset:12288
    ds_write_b64 v2, v[188:189] offset:13312
    ds_write_b64 v2, v[192:193] offset:14336
    ds_write_b64 v2, v[196:197] offset:15360
    v_cvt_pk_bf16_f32 v200, v200, v201
    v_cvt_pk_bf16_f32 v201, v202, v203
    v_pk_max_i16 v200, v200, 0
    v_pk_max_i16 v201, v201, 0
    v_cvt_pk_bf16_f32 v204, v204, v205
    v_cvt_pk_bf16_f32 v205, v206, v207
    v_pk_max_i16 v204, v204, 0
    v_pk_max_i16 v205, v205, 0
    v_cvt_pk_bf16_f32 v208, v208, v209
    v_cvt_pk_bf16_f32 v209, v210, v211
    v_pk_max_i16 v208, v208, 0
    v_pk_max_i16 v209, v209, 0
    v_cvt_pk_bf16_f32 v212, v212, v213
    v_cvt_pk_bf16_f32 v213, v214, v215
    v_pk_max_i16 v212, v212, 0
    v_pk_max_i16 v213, v213, 0
    ds_write_b64 v4, v[200:201] offset:12288
    ds_write_b64 v4, v[204:205] offset:13312
    s_waitcnt lgkmcnt(8)
    ds_write_b64 v4, v[208:209] offset:14336
    ds_write_b64 v4, v[212:213] offset:15360
    v_cvt_pk_bf16_f32 v216, v216, v217
    v_cvt_pk_bf16_f32 v217, v218, v219
    v_pk_max_i16 v216, v216, 0
    v_pk_max_i16 v217, v217, 0
    v_cvt_pk_bf16_f32 v220, v220, v221
    v_cvt_pk_bf16_f32 v221, v222, v223
    v_pk_max_i16 v220, v220, 0
    v_pk_max_i16 v221, v221, 0
    v_cvt_pk_bf16_f32 v224, v224, v225
    v_cvt_pk_bf16_f32 v225, v226, v227
    v_pk_max_i16 v224, v224, 0
    v_pk_max_i16 v225, v225, 0
    v_cvt_pk_bf16_f32 v228, v228, v229
    v_cvt_pk_bf16_f32 v229, v230, v231
    v_pk_max_i16 v228, v228, 0
    v_pk_max_i16 v229, v229, 0
    ds_write_b64 v2, v[216:217] offset:16384
    ds_write_b64 v2, v[220:221] offset:17408
    ds_write_b64 v2, v[224:225] offset:18432
    ds_write_b64 v2, v[228:229] offset:19456
    v_add_u32 v2, s44, v1
    v_add_u32 v4, 36864, v2
    v_add_u32 v5, 36864, v9
    v_add_u32 v6, 36864, v10
    s_mov_b32 s47, -73728
    s_mov_b32 s46, 0
    s_waitcnt lgkmcnt(0)
    s_barrier
    ds_read_b128 v[88:91], v2 offset:0
    ds_read_b128 v[92:95], v2 offset:1024
    ds_read_b128 v[96:99], v2 offset:4096
    ds_read_b128 v[100:103], v2 offset:5120
    ds_read_b128 v[104:107], v2 offset:8192
    ds_read_b128 v[108:111], v2 offset:9216
    ds_read_b128 v[112:115], v2 offset:12288
    ds_read_b128 v[116:119], v2 offset:13312
    ds_read_b128 v[120:123], v2 offset:16384
    ds_read_b128 v[124:127], v2 offset:17408
    s_waitcnt lgkmcnt(9)
    v_mfma_f32_16x16x32_bf16 v[48:51], v[12:15], v[88:91], 0
    ds_read_b64_tr_b16 v[40:41], v10 offset:12288
    ds_read_b128 v[128:131], v2 offset:20480
    ds_read_b128 v[132:135], v2 offset:21504
    s_waitcnt lgkmcnt(11)
    v_mfma_f32_16x16x32_bf16 v[52:55], v[12:15], v[92:95], 0
    ds_read_b64_tr_b16 v[42:43], v10 offset:14336
    ds_read_b128 v[136:139], v2 offset:24576
    v_mfma_f32_16x16x32_bf16 v[56:59], v[16:19], v[88:91], 0
    ds_read_b64_tr_b16 v[44:45], v9 offset:16384
    ds_read_b128 v[140:143], v2 offset:25600
    v_mfma_f32_16x16x32_bf16 v[60:63], v[16:19], v[92:95], 0
    s_waitcnt lgkmcnt(14)
    ds_read_b64_tr_b16 v[46:47], v9 offset:18432
    s_waitcnt lgkmcnt(14)
    ds_read_b128 v[144:147], v2 offset:28672
    s_waitcnt lgkmcnt(14)
    ds_read_b128 v[148:151], v2 offset:29696
    v_mfma_f32_16x16x32_bf16 v[48:51], v[20:23], v[96:99], v[48:51]
    s_waitcnt lgkmcnt(14)
    ds_read_b64_tr_b16 v[12:13], v10 offset:16384
    s_waitcnt lgkmcnt(14)
    ds_read_b128 v[152:155], v2 offset:32768
    v_mfma_f32_16x16x32_bf16 v[52:55], v[20:23], v[100:103], v[52:55]
    s_waitcnt lgkmcnt(14)
    ds_read_b64_tr_b16 v[14:15], v10 offset:18432
    s_waitcnt lgkmcnt(14)
    ds_read_b128 v[156:159], v2 offset:33792
    v_mfma_f32_16x16x32_bf16 v[56:59], v[24:27], v[96:99], v[56:59]
    s_waitcnt lgkmcnt(14)
    ds_read_b64_tr_b16 v[16:17], v9 offset:20480
    v_mfma_f32_16x16x32_bf16 v[60:63], v[24:27], v[100:103], v[60:63]
    s_waitcnt lgkmcnt(14)
    ds_read_b64_tr_b16 v[18:19], v9 offset:22528
    v_mfma_f32_16x16x32_bf16 v[48:51], v[28:31], v[104:107], v[48:51]
    s_waitcnt lgkmcnt(14)
    ds_read_b64_tr_b16 v[20:21], v10 offset:20480
    v_mfma_f32_16x16x32_bf16 v[52:55], v[28:31], v[108:111], v[52:55]
    s_waitcnt lgkmcnt(14)
    ds_read_b64_tr_b16 v[22:23], v10 offset:22528
    s_waitcnt lgkmcnt(0)
    s_barrier
    v_mfma_f32_16x16x32_bf16 v[56:59], v[32:35], v[104:107], v[56:59]
    ds_read_b64_tr_b16 v[24:25], v9 offset:24576
    ds_read_b128 v[160:163], v4 offset:0
    ds_read_b128 v[164:167], v4 offset:1024
    v_mfma_f32_16x16x32_bf16 v[60:63], v[32:35], v[108:111], v[60:63]
    ds_read_b64_tr_b16 v[26:27], v9 offset:26624
    ds_read_b128 v[168:171], v4 offset:4096
    v_mfma_f32_16x16x32_bf16 v[48:51], v[36:39], v[112:115], v[48:51]
    ds_read_b64_tr_b16 v[28:29], v10 offset:24576
    ds_read_b128 v[172:175], v4 offset:5120
    ds_read_b128 v[176:179], v4 offset:8192
    v_mfma_f32_16x16x32_bf16 v[52:55], v[36:39], v[116:119], v[52:55]
    ds_read_b64_tr_b16 v[30:31], v10 offset:26624
    ds_read_b128 v[180:183], v4 offset:9216
    v_mfma_f32_16x16x32_bf16 v[56:59], v[40:43], v[112:115], v[56:59]
    ds_read_b64_tr_b16 v[32:33], v9 offset:28672
    ds_read_b128 v[184:187], v4 offset:12288
    v_mfma_f32_16x16x32_bf16 v[60:63], v[40:43], v[116:119], v[60:63]
    ds_read_b64_tr_b16 v[34:35], v9 offset:30720
    ds_read_b128 v[188:191], v4 offset:13312
    ds_read_b128 v[192:195], v4 offset:16384
    v_mfma_f32_16x16x32_bf16 v[48:51], v[44:47], v[120:123], v[48:51]
    s_waitcnt lgkmcnt(14)
    ds_read_b64_tr_b16 v[36:37], v10 offset:28672
    s_waitcnt lgkmcnt(14)
    ds_read_b128 v[196:199], v4 offset:17408
    v_mfma_f32_16x16x32_bf16 v[52:55], v[44:47], v[124:127], v[52:55]
    s_waitcnt lgkmcnt(14)
    ds_read_b64_tr_b16 v[38:39], v10 offset:30720
    s_waitcnt lgkmcnt(14)
    ds_read_b128 v[200:203], v4 offset:20480
    s_waitcnt lgkmcnt(14)
    ds_read_b128 v[204:207], v4 offset:21504
    v_mfma_f32_16x16x32_bf16 v[56:59], v[12:15], v[120:123], v[56:59]
    s_waitcnt lgkmcnt(14)
    ds_read_b64_tr_b16 v[40:41], v9 offset:32768
    s_waitcnt lgkmcnt(14)
    ds_read_b128 v[208:211], v4 offset:24576
    v_mfma_f32_16x16x32_bf16 v[60:63], v[12:15], v[124:127], v[60:63]
    s_waitcnt lgkmcnt(14)
    ds_read_b64_tr_b16 v[42:43], v9 offset:34816
    s_waitcnt lgkmcnt(14)
    ds_read_b128 v[212:215], v4 offset:25600
    v_mfma_f32_16x16x32_bf16 v[48:51], v[16:19], v[128:131], v[48:51]
    s_waitcnt lgkmcnt(14)
    ds_read_b64_tr_b16 v[44:45], v10 offset:32768
    s_waitcnt lgkmcnt(14)
    ds_read_b128 v[216:219], v4 offset:28672
    s_waitcnt lgkmcnt(14)
    ds_read_b128 v[220:223], v4 offset:29696
    v_mfma_f32_16x16x32_bf16 v[52:55], v[16:19], v[132:135], v[52:55]
    s_waitcnt lgkmcnt(14)
    ds_read_b64_tr_b16 v[46:47], v10 offset:34816
    s_waitcnt lgkmcnt(14)
    ds_read_b128 v[224:227], v4 offset:32768
    v_mfma_f32_16x16x32_bf16 v[56:59], v[20:23], v[128:131], v[56:59]
    v_add_u32 v9, s47, v9
    s_waitcnt lgkmcnt(14)
    ds_read_b128 v[228:231], v4 offset:33792
    v_mfma_f32_16x16x32_bf16 v[60:63], v[20:23], v[132:135], v[60:63]
    v_add_u32 v10, s47, v10
    v_mfma_f32_16x16x32_bf16 v[48:51], v[24:27], v[136:139], v[48:51]
    v_mfma_f32_16x16x32_bf16 v[52:55], v[24:27], v[140:143], v[52:55]
    s_waitcnt lgkmcnt(0)
    s_barrier
    v_mfma_f32_16x16x32_bf16 v[56:59], v[28:31], v[136:139], v[56:59]
    ds_read_b64_tr_b16 v[12:13], v5 offset:0
    ds_read_b64_tr_b16 v[14:15], v5 offset:2048
    v_mfma_f32_16x16x32_bf16 v[60:63], v[28:31], v[140:143], v[60:63]
    ds_read_b64_tr_b16 v[16:17], v6 offset:0
    ds_read_b64_tr_b16 v[18:19], v6 offset:2048
    v_mfma_f32_16x16x32_bf16 v[48:51], v[32:35], v[144:147], v[48:51]
    ds_read_b64_tr_b16 v[20:21], v5 offset:4096
    ds_read_b64_tr_b16 v[22:23], v5 offset:6144
    v_mfma_f32_16x16x32_bf16 v[52:55], v[32:35], v[148:151], v[52:55]
    ds_read_b64_tr_b16 v[24:25], v6 offset:4096
    v_mfma_f32_16x16x32_bf16 v[56:59], v[36:39], v[144:147], v[56:59]
    ds_read_b64_tr_b16 v[26:27], v6 offset:6144
    ds_read_b64_tr_b16 v[28:29], v5 offset:8192
    v_mfma_f32_16x16x32_bf16 v[60:63], v[36:39], v[148:151], v[60:63]
    ds_read_b64_tr_b16 v[30:31], v5 offset:10240
    v_mfma_f32_16x16x32_bf16 v[48:51], v[40:43], v[152:155], v[48:51]
    ds_read_b64_tr_b16 v[32:33], v6 offset:8192
    v_mfma_f32_16x16x32_bf16 v[52:55], v[40:43], v[156:159], v[52:55]
    ds_read_b64_tr_b16 v[34:35], v6 offset:10240
    v_mfma_f32_16x16x32_bf16 v[56:59], v[44:47], v[152:155], v[56:59]
    ds_read_b64_tr_b16 v[36:37], v5 offset:12288
    v_mfma_f32_16x16x32_bf16 v[60:63], v[44:47], v[156:159], v[60:63]
    ds_read_b64_tr_b16 v[38:39], v5 offset:14336
    s_waitcnt lgkmcnt(10)
    v_mfma_f32_16x16x32_bf16 v[48:51], v[12:15], v[160:163], v[48:51]
    ds_read_b64_tr_b16 v[40:41], v6 offset:12288
    v_mfma_f32_16x16x32_bf16 v[52:55], v[12:15], v[164:167], v[52:55]
    ds_read_b64_tr_b16 v[42:43], v6 offset:14336
    v_mfma_f32_16x16x32_bf16 v[56:59], v[16:19], v[160:163], v[56:59]
    ds_read_b64_tr_b16 v[44:45], v5 offset:16384
    v_mfma_f32_16x16x32_bf16 v[60:63], v[16:19], v[164:167], v[60:63]
    ds_read_b64_tr_b16 v[46:47], v5 offset:18432
    s_waitcnt lgkmcnt(10)
    v_mfma_f32_16x16x32_bf16 v[48:51], v[20:23], v[168:171], v[48:51]
    ds_read_b64_tr_b16 v[12:13], v6 offset:16384
    v_mfma_f32_16x16x32_bf16 v[52:55], v[20:23], v[172:175], v[52:55]
    ds_read_b64_tr_b16 v[14:15], v6 offset:18432
    v_mfma_f32_16x16x32_bf16 v[56:59], v[24:27], v[168:171], v[56:59]
    ds_read_b64_tr_b16 v[16:17], v5 offset:20480
    v_mfma_f32_16x16x32_bf16 v[60:63], v[24:27], v[172:175], v[60:63]
    ds_read_b64_tr_b16 v[18:19], v5 offset:22528
    s_waitcnt lgkmcnt(10)
    v_mfma_f32_16x16x32_bf16 v[48:51], v[28:31], v[176:179], v[48:51]
    ds_read_b64_tr_b16 v[20:21], v6 offset:20480
    v_mfma_f32_16x16x32_bf16 v[52:55], v[28:31], v[180:183], v[52:55]
    ds_read_b64_tr_b16 v[22:23], v6 offset:22528
    v_mfma_f32_16x16x32_bf16 v[56:59], v[32:35], v[176:179], v[56:59]
    ds_read_b64_tr_b16 v[24:25], v5 offset:24576
    v_mfma_f32_16x16x32_bf16 v[60:63], v[32:35], v[180:183], v[60:63]
    ds_read_b64_tr_b16 v[26:27], v5 offset:26624
    s_waitcnt lgkmcnt(10)
    v_mfma_f32_16x16x32_bf16 v[48:51], v[36:39], v[184:187], v[48:51]
    ds_read_b64_tr_b16 v[28:29], v6 offset:24576
    v_mfma_f32_16x16x32_bf16 v[52:55], v[36:39], v[188:191], v[52:55]
    ds_read_b64_tr_b16 v[30:31], v6 offset:26624
    v_mfma_f32_16x16x32_bf16 v[56:59], v[40:43], v[184:187], v[56:59]
    ds_read_b64_tr_b16 v[32:33], v5 offset:28672
    v_mfma_f32_16x16x32_bf16 v[60:63], v[40:43], v[188:191], v[60:63]
    ds_read_b64_tr_b16 v[34:35], v5 offset:30720
    s_waitcnt lgkmcnt(10)
    v_mfma_f32_16x16x32_bf16 v[48:51], v[44:47], v[192:195], v[48:51]
    ds_read_b64_tr_b16 v[36:37], v6 offset:28672
    v_mfma_f32_16x16x32_bf16 v[52:55], v[44:47], v[196:199], v[52:55]
    ds_read_b64_tr_b16 v[38:39], v6 offset:30720
    v_mfma_f32_16x16x32_bf16 v[56:59], v[12:15], v[192:195], v[56:59]
    ds_read_b64_tr_b16 v[40:41], v5 offset:32768
    v_mfma_f32_16x16x32_bf16 v[60:63], v[12:15], v[196:199], v[60:63]
    ds_read_b64_tr_b16 v[42:43], v5 offset:34816
    s_waitcnt lgkmcnt(10)
    v_mfma_f32_16x16x32_bf16 v[48:51], v[16:19], v[200:203], v[48:51]
    ds_read_b64_tr_b16 v[44:45], v6 offset:32768
    v_mfma_f32_16x16x32_bf16 v[52:55], v[16:19], v[204:207], v[52:55]
    ds_read_b64_tr_b16 v[46:47], v6 offset:34816
    v_mfma_f32_16x16x32_bf16 v[56:59], v[20:23], v[200:203], v[56:59]
    v_add_u32 v5, s47, v5
    v_mfma_f32_16x16x32_bf16 v[60:63], v[20:23], v[204:207], v[60:63]
    v_add_u32 v6, s47, v6
    s_waitcnt lgkmcnt(8)
    v_mfma_f32_16x16x32_bf16 v[48:51], v[24:27], v[208:211], v[48:51]
    v_mfma_f32_16x16x32_bf16 v[52:55], v[24:27], v[212:215], v[52:55]
    s_waitcnt lgkmcnt(0)
    s_barrier
    v_mfma_f32_16x16x32_bf16 v[56:59], v[28:31], v[208:211], v[56:59]
    ds_read_b64_tr_b16 v[12:13], v9 offset:0
    ds_read_b64_tr_b16 v[14:15], v9 offset:2048
    v_mfma_f32_16x16x32_bf16 v[60:63], v[28:31], v[212:215], v[60:63]
    ds_read_b64_tr_b16 v[16:17], v10 offset:0
    ds_read_b64_tr_b16 v[18:19], v10 offset:2048
    v_mfma_f32_16x16x32_bf16 v[48:51], v[32:35], v[216:219], v[48:51]
    ds_read_b64_tr_b16 v[20:21], v9 offset:4096
    ds_read_b64_tr_b16 v[22:23], v9 offset:6144
    v_mfma_f32_16x16x32_bf16 v[52:55], v[32:35], v[220:223], v[52:55]
    ds_read_b64_tr_b16 v[24:25], v10 offset:4096
    v_mfma_f32_16x16x32_bf16 v[56:59], v[36:39], v[216:219], v[56:59]
    ds_read_b64_tr_b16 v[26:27], v10 offset:6144
    ds_read_b64_tr_b16 v[28:29], v9 offset:8192
    v_mfma_f32_16x16x32_bf16 v[60:63], v[36:39], v[220:223], v[60:63]
    ds_read_b64_tr_b16 v[30:31], v9 offset:10240
    v_mfma_f32_16x16x32_bf16 v[64:67], v[40:43], v[224:227], v[48:51]
    ds_read_b64_tr_b16 v[32:33], v10 offset:8192
    v_mfma_f32_16x16x32_bf16 v[68:71], v[40:43], v[228:231], v[52:55]
    ds_read_b64_tr_b16 v[34:35], v10 offset:10240
    v_mfma_f32_16x16x32_bf16 v[72:75], v[44:47], v[224:227], v[56:59]
    ds_read_b64_tr_b16 v[36:37], v9 offset:12288
    s_sub_u32 s47, 0, s47
    v_mfma_f32_16x16x32_bf16 v[76:79], v[44:47], v[228:231], v[60:63]
    ds_read_b64_tr_b16 v[38:39], v9 offset:14336
    .p2align 6
k4_l2_36:
    s_waitcnt lgkmcnt(10)
    v_mfma_f32_16x16x32_bf16 v[48:51], v[12:15], v[88:91], 0
    ds_read_b64_tr_b16 v[40:41], v10 offset:12288
    v_mfma_f32_16x16x32_bf16 v[52:55], v[12:15], v[92:95], 0
    ds_read_b64_tr_b16 v[42:43], v10 offset:14336
    v_mfma_f32_16x16x32_bf16 v[56:59], v[16:19], v[88:91], 0
    ds_read_b64_tr_b16 v[44:45], v9 offset:16384
    s_cmp_lg_u32 s46, 7
    s_cbranch_scc1 k4_ne_37
    s_waitcnt vmcnt(2)
    buffer_atomic_add v233, v232, s[16:19], s50 offen
k4_ne_37:
    v_mfma_f32_16x16x32_bf16 v[60:63], v[16:19], v[92:95], 0
    ds_read_b64_tr_b16 v[46:47], v9 offset:18432
    s_waitcnt lgkmcnt(10)
    v_mfma_f32_16x16x32_bf16 v[48:51], v[20:23], v[96:99], v[48:51]
    ds_read_b64_tr_b16 v[12:13], v10 offset:16384
    v_mfma_f32_16x16x32_bf16 v[52:55], v[20:23], v[100:103], v[52:55]
    ds_read_b64_tr_b16 v[14:15], v10 offset:18432
    v_mfma_f32_16x16x32_bf16 v[56:59], v[24:27], v[96:99], v[56:59]
    ds_read_b64_tr_b16 v[16:17], v9 offset:20480
    v_cvt_pk_bf16_f32 v80, v64, v65
    v_mfma_f32_16x16x32_bf16 v[60:63], v[24:27], v[100:103], v[60:63]
    ds_read_b64_tr_b16 v[18:19], v9 offset:22528
    v_cvt_pk_bf16_f32 v81, v66, v67
    s_waitcnt lgkmcnt(10)
    v_mfma_f32_16x16x32_bf16 v[48:51], v[28:31], v[104:107], v[48:51]
    ds_read_b64_tr_b16 v[20:21], v10 offset:20480
    v_mfma_f32_16x16x32_bf16 v[52:55], v[28:31], v[108:111], v[52:55]
    ds_read_b64_tr_b16 v[22:23], v10 offset:22528
    v_cvt_pk_bf16_f32 v82, v68, v69
    v_mfma_f32_16x16x32_bf16 v[56:59], v[32:35], v[104:107], v[56:59]
    ds_read_b64_tr_b16 v[24:25], v9 offset:24576
    v_mfma_f32_16x16x32_bf16 v[60:63], v[32:35], v[108:111], v[60:63]
    ds_read_b64_tr_b16 v[26:27], v9 offset:26624
    v_cvt_pk_bf16_f32 v83, v70, v71
    s_waitcnt lgkmcnt(10)
    v_mfma_f32_16x16x32_bf16 v[48:51], v[36:39], v[112:115], v[48:51]
    ds_read_b64_tr_b16 v[28:29], v10 offset:24576
    v_mfma_f32_16x16x32_bf16 v[52:55], v[36:39], v[116:119], v[52:55]
    ds_read_b64_tr_b16 v[30:31], v10 offset:26624
    buffer_store_dwordx4 v[80:83], v1, s[16:19], s33 offen offset:0 sc1
    v_mfma_f32_16x16x32_bf16 v[56:59], v[40:43], v[112:115], v[56:59]
    ds_read_b64_tr_b16 v[32:33], v9 offset:28672
    v_mfma_f32_16x16x32_bf16 v[60:63], v[40:43], v[116:119], v[60:63]
    ds_read_b64_tr_b16 v[34:35], v9 offset:30720
    v_cvt_pk_bf16_f32 v84, v72, v73
    s_waitcnt lgkmcnt(10)
    v_mfma_f32_16x16x32_bf16 v[48:51], v[44:47], v[120:123], v[48:51]
    ds_read_b64_tr_b16 v[36:37], v10 offset:28672
    v_cvt_pk_bf16_f32 v85, v74, v75
    v_mfma_f32_16x16x32_bf16 v[52:55], v[44:47], v[124:127], v[52:55]
    ds_read_b64_tr_b16 v[38:39], v10 offset:30720
    v_mfma_f32_16x16x32_bf16 v[56:59], v[12:15], v[120:123], v[56:59]
    ds_read_b64_tr_b16 v[40:41], v9 offset:32768
    v_cvt_pk_bf16_f32 v86, v76, v77
    v_mfma_f32_16x16x32_bf16 v[60:63], v[12:15], v[124:127], v[60:63]
    ds_read_b64_tr_b16 v[42:43], v9 offset:34816
    s_waitcnt lgkmcnt(10)
    v_mfma_f32_16x16x32_bf16 v[48:51], v[16:19], v[128:131], v[48:51]
    ds_read_b64_tr_b16 v[44:45], v10 offset:32768
    v_cvt_pk_bf16_f32 v87, v78, v79
    v_mfma_f32_16x16x32_bf16 v[52:55], v[16:19], v[132:135], v[52:55]
    ds_read_b64_tr_b16 v[46:47], v10 offset:34816
    v_mfma_f32_16x16x32_bf16 v[56:59], v[20:23], v[128:131], v[56:59]
    v_add_u32 v9, s47, v9
    buffer_store_dwordx4 v[84:87], v1, s[16:19], s33 offen offset:2048 sc1
    v_mfma_f32_16x16x32_bf16 v[60:63], v[20:23], v[132:135], v[60:63]
    v_add_u32 v10, s47, v10
    s_waitcnt lgkmcnt(8)
    v_mfma_f32_16x16x32_bf16 v[48:51], v[24:27], v[136:139], v[48:51]
    v_mfma_f32_16x16x32_bf16 v[52:55], v[24:27], v[140:143], v[52:55]
    s_waitcnt lgkmcnt(0)
    s_barrier
    v_mfma_f32_16x16x32_bf16 v[56:59], v[28:31], v[136:139], v[56:59]
    ds_read_b64_tr_b16 v[12:13], v5 offset:0
    ds_read_b64_tr_b16 v[14:15], v5 offset:2048
    v_mfma_f32_16x16x32_bf16 v[60:63], v[28:31], v[140:143], v[60:63]
    ds_read_b64_tr_b16 v[16:17], v6 offset:0
    ds_read_b64_tr_b16 v[18:19], v6 offset:2048
    v_mfma_f32_16x16x32_bf16 v[48:51], v[32:35], v[144:147], v[48:51]
    ds_read_b64_tr_b16 v[20:21], v5 offset:4096
    ds_read_b64_tr_b16 v[22:23], v5 offset:6144
    v_mfma_f32_16x16x32_bf16 v[52:55], v[32:35], v[148:151], v[52:55]
    ds_read_b64_tr_b16 v[24:25], v6 offset:4096
    v_mfma_f32_16x16x32_bf16 v[56:59], v[36:39], v[144:147], v[56:59]
    ds_read_b64_tr_b16 v[26:27], v6 offset:6144
    ds_read_b64_tr_b16 v[28:29], v5 offset:8192
    v_mfma_f32_16x16x32_bf16 v[60:63], v[36:39], v[148:151], v[60:63]
    ds_read_b64_tr_b16 v[30:31], v5 offset:10240
    v_mfma_f32_16x16x32_bf16 v[48:51], v[40:43], v[152:155], v[48:51]
    ds_read_b64_tr_b16 v[32:33], v6 offset:8192
    v_mfma_f32_16x16x32_bf16 v[52:55], v[40:43], v[156:159], v[52:55]
    ds_read_b64_tr_b16 v[34:35], v6 offset:10240
    v_mfma_f32_16x16x32_bf16 v[56:59], v[44:47], v[152:155], v[56:59]
    ds_read_b64_tr_b16 v[36:37], v5 offset:12288
    v_mfma_f32_16x16x32_bf16 v[60:63], v[44:47], v[156:159], v[60:63]
    ds_read_b64_tr_b16 v[38:39], v5 offset:14336
    s_waitcnt lgkmcnt(10)
    v_mfma_f32_16x16x32_bf16 v[48:51], v[12:15], v[160:163], v[48:51]
    ds_read_b64_tr_b16 v[40:41], v6 offset:12288
    v_mfma_f32_16x16x32_bf16 v[52:55], v[12:15], v[164:167], v[52:55]
    ds_read_b64_tr_b16 v[42:43], v6 offset:14336
    v_mfma_f32_16x16x32_bf16 v[56:59], v[16:19], v[160:163], v[56:59]
    ds_read_b64_tr_b16 v[44:45], v5 offset:16384
    v_mfma_f32_16x16x32_bf16 v[60:63], v[16:19], v[164:167], v[60:63]
    ds_read_b64_tr_b16 v[46:47], v5 offset:18432
    s_waitcnt lgkmcnt(10)
    v_mfma_f32_16x16x32_bf16 v[48:51], v[20:23], v[168:171], v[48:51]
    ds_read_b64_tr_b16 v[12:13], v6 offset:16384
    v_mfma_f32_16x16x32_bf16 v[52:55], v[20:23], v[172:175], v[52:55]
    ds_read_b64_tr_b16 v[14:15], v6 offset:18432
    v_mfma_f32_16x16x32_bf16 v[56:59], v[24:27], v[168:171], v[56:59]
    ds_read_b64_tr_b16 v[16:17], v5 offset:20480
    v_mfma_f32_16x16x32_bf16 v[60:63], v[24:27], v[172:175], v[60:63]
    ds_read_b64_tr_b16 v[18:19], v5 offset:22528
    s_waitcnt lgkmcnt(10)
    v_mfma_f32_16x16x32_bf16 v[48:51], v[28:31], v[176:179], v[48:51]
    ds_read_b64_tr_b16 v[20:21], v6 offset:20480
    v_mfma_f32_16x16x32_bf16 v[52:55], v[28:31], v[180:183], v[52:55]
    ds_read_b64_tr_b16 v[22:23], v6 offset:22528
    v_mfma_f32_16x16x32_bf16 v[56:59], v[32:35], v[176:179], v[56:59]
    ds_read_b64_tr_b16 v[24:25], v5 offset:24576
    v_mfma_f32_16x16x32_bf16 v[60:63], v[32:35], v[180:183], v[60:63]
    ds_read_b64_tr_b16 v[26:27], v5 offset:26624
    s_waitcnt lgkmcnt(10)
    v_mfma_f32_16x16x32_bf16 v[48:51], v[36:39], v[184:187], v[48:51]
    ds_read_b64_tr_b16 v[28:29], v6 offset:24576
    v_mfma_f32_16x16x32_bf16 v[52:55], v[36:39], v[188:191], v[52:55]
    ds_read_b64_tr_b16 v[30:31], v6 offset:26624
    v_mfma_f32_16x16x32_bf16 v[56:59], v[40:43], v[184:187], v[56:59]
    ds_read_b64_tr_b16 v[32:33], v5 offset:28672
    v_mfma_f32_16x16x32_bf16 v[60:63], v[40:43], v[188:191], v[60:63]
    ds_read_b64_tr_b16 v[34:35], v5 offset:30720
    s_waitcnt lgkmcnt(10)
    v_mfma_f32_16x16x32_bf16 v[48:51], v[44:47], v[192:195], v[48:51]
    ds_read_b64_tr_b16 v[36:37], v6 offset:28672
    v_mfma_f32_16x16x32_bf16 v[52:55], v[44:47], v[196:199], v[52:55]
    ds_read_b64_tr_b16 v[38:39], v6 offset:30720
    v_mfma_f32_16x16x32_bf16 v[56:59], v[12:15], v[192:195], v[56:59]
    ds_read_b64_tr_b16 v[40:41], v5 offset:32768
    v_mfma_f32_16x16x32_bf16 v[60:63], v[12:15], v[196:199], v[60:63]
    ds_read_b64_tr_b16 v[42:43], v5 offset:34816
    s_waitcnt lgkmcnt(10)
    v_mfma_f32_16x16x32_bf16 v[48:51], v[16:19], v[200:203], v[48:51]
    ds_read_b64_tr_b16 v[44:45], v6 offset:32768
    v_mfma_f32_16x16x32_bf16 v[52:55], v[16:19], v[204:207], v[52:55]
    ds_read_b64_tr_b16 v[46:47], v6 offset:34816
    v_mfma_f32_16x16x32_bf16 v[56:59], v[20:23], v[200:203], v[56:59]
    v_add_u32 v5, s47, v5
    v_mfma_f32_16x16x32_bf16 v[60:63], v[20:23], v[204:207], v[60:63]
    v_add_u32 v6, s47, v6
    s_waitcnt lgkmcnt(8)
    v_mfma_f32_16x16x32_bf16 v[48:51], v[24:27], v[208:211], v[48:51]
    s_cmp_eq_u32 s46, 7
    v_mfma_f32_16x16x32_bf16 v[52:55], v[24:27], v[212:215], v[52:55]
    s_waitcnt lgkmcnt(0)
    s_cbranch_scc1 k4_nb_38
    s_barrier
k4_nb_38:
    v_mfma_f32_16x16x32_bf16 v[56:59], v[28:31], v[208:211], v[56:59]
    ds_read_b64_tr_b16 v[12:13], v9 offset:0
    ds_read_b64_tr_b16 v[14:15], v9 offset:2048
    v_mfma_f32_16x16x32_bf16 v[60:63], v[28:31], v[212:215], v[60:63]
    ds_read_b64_tr_b16 v[16:17], v10 offset:0
    ds_read_b64_tr_b16 v[18:19], v10 offset:2048
    v_mfma_f32_16x16x32_bf16 v[48:51], v[32:35], v[216:219], v[48:51]
    ds_read_b64_tr_b16 v[20:21], v9 offset:4096
    ds_read_b64_tr_b16 v[22:23], v9 offset:6144
    s_add_u32 s51, s51, 1
    s_and_b32 s51, s51, 7
    v_mfma_f32_16x16x32_bf16 v[52:55], v[32:35], v[220:223], v[52:55]
    ds_read_b64_tr_b16 v[24:25], v10 offset:4096
    v_mfma_f32_16x16x32_bf16 v[56:59], v[36:39], v[216:219], v[56:59]
    ds_read_b64_tr_b16 v[26:27], v10 offset:6144
    ds_read_b64_tr_b16 v[28:29], v9 offset:8192
    s_lshl_b32 s33, s51, 13
    s_add_u32 s33, s33, s48
    v_mfma_f32_16x16x32_bf16 v[60:63], v[36:39], v[220:223], v[60:63]
    ds_read_b64_tr_b16 v[30:31], v9 offset:10240
    v_mfma_f32_16x16x32_bf16 v[64:67], v[40:43], v[224:227], v[48:51]
    ds_read_b64_tr_b16 v[32:33], v10 offset:8192
    v_mfma_f32_16x16x32_bf16 v[68:71], v[40:43], v[228:231], v[52:55]
    ds_read_b64_tr_b16 v[34:35], v10 offset:10240
    v_mfma_f32_16x16x32_bf16 v[72:75], v[44:47], v[224:227], v[56:59]
    ds_read_b64_tr_b16 v[36:37], v9 offset:12288
    s_sub_u32 s47, 0, s47
    s_add_u32 s46, s46, 1
    v_mfma_f32_16x16x32_bf16 v[76:79], v[44:47], v[228:231], v[60:63]
    ds_read_b64_tr_b16 v[38:39], v9 offset:14336
    s_cmp_lt_u32 s46, 8
    s_cbranch_scc1 k4_l2_36
    s_waitcnt vmcnt(0)
    buffer_atomic_add v233, v234, s[16:19], s50 offen
    s_lshl_b32 s52, s30, 12
    v_add_u32 v2, s52, v1
    s_nop 4
    ds_write_b128 v2, v[64:67] offset:0
    ds_write_b128 v2, v[68:71] offset:1024
    ds_write_b128 v2, v[72:75] offset:2048
    ds_write_b128 v2, v[76:79] offset:3072
    s_waitcnt lgkmcnt(0)
    s_cmp_lg_u32 s30, 3
    s_cbranch_scc1 k4_n8_39
    v_lshlrev_b32 v2, 2, v3
    v_cmp_gt_u32 vcc, 8, v3
    v_mov_b32 v4, 0x40000000
    s_mul_i32 s63, s29, 1152
    s_add_u32 s63, s63, 327680
    v_cndmask_b32 v2, v4, v2, vcc
    s_mov_b32 s69, 0
    s_add_u32 s59, s63, 1024
    s_and_b32 s60, s69, 255
    s_cmp_eq_u32 s60, 255
    s_cbranch_scc1 k4_polld_41
    s_mov_b32 s61, 0
k4_poll_40:
    v_mov_b32 v4, 0
    buffer_atomic_add v4, v2, s[16:19], s59 offen sc0
    s_waitcnt vmcnt(0)
    v_cmp_eq_u32 vcc, 4, v4
    s_add_u32 s61, s61, 1
    s_mov_b32 s69, vcc_lo
    s_and_b32 s60, s69, 255
    s_cmp_eq_u32 s60, 255
    s_cbranch_scc1 k4_polld_41
    s_cmp_lt_u32 s61, 0x40000
    s_cbranch_scc1 k4_poll_40
k4_polld_41:
    s_mul_i32 s60, s29, 73728
    s_lshl_b32 s61, s28, 10
    s_add_u32 s60, s60, s61
    s_add_u32 s60, s60, 18939904
    buffer_load_dwordx4 v[112:115], v1, s[16:19], s60 offen sc1
    s_add_u32 s60, s60, 2359296
    buffer_load_dwordx4 v[116:119], v1, s[16:19], s60 offen sc1
    s_add_u32 s60, s60, 2359296
    buffer_load_dwordx4 v[120:123], v1, s[16:19], s60 offen sc1
    s_add_u32 s60, s60, 2359296
    buffer_load_dwordx4 v[124:127], v1, s[16:19], s60 offen sc1
    s_add_u32 s60, s60, 2359296
    buffer_load_dwordx4 v[128:131], v1, s[16:19], s60 offen sc1
    s_add_u32 s60, s60, 2359296
    buffer_load_dwordx4 v[132:135], v1, s[16:19], s60 offen sc1
    s_add_u32 s60, s60, 2359296
    buffer_load_dwordx4 v[136:139], v1, s[16:19], s60 offen sc1
    s_add_u32 s60, s60, 2359296
    buffer_load_dwordx4 v[140:143], v1, s[16:19], s60 offen sc1
    s_add_u32 s60, s60, 2359296
    s_lshr_b32 s68, s28, 1
    s_add_u32 s68, s68, 32
    s_and_b32 s59, s28, 1
    v_lshrrev_b32 v99, 4, v3
    s_lshl_b32 s54, s68, 2
    v_add_u32 v99, s54, v99
    s_lshl_b32 s55, s29, 1
    s_add_u32 s55, s55, s59
    s_mul_i32 s56, s55, 36864
    s_add_u32 s56, s56, 3145728
    s_add_u32 s57, s56, 18432
    v_lshlrev_b32 v97, 4, v99
    s_mov_b32 s54, 11520
    buffer_load_dwordx4 v[100:103], v97, s[16:19], s54 offen
    s_lshl_b32 s55, s55, 5
    v_and_b32 v98, 15, v3
    v_add_u32 v96, s55, v98
    v_mul_u32_u24 v96, 1152, v96
    v_lshl_add_u32 v96, v99, 3, v96
    v_lshlrev_b32 v98, 4, v98
    s_cmp_lt_u32 s68, 18
    s_cbranch_scc1 ob_j_43
    v_sub_u32 v99, 216, v99
    v_cmp_eq_u32 vcc, 144, v99
    v_mov_b32 v108, 72
    s_nop 0
    v_cndmask_b32 v108, v99, v108, vcc
    v_lshrrev_b32 v109, 1, v108
    v_lshl_add_u32 v97, v109, 8, v98
    v_and_b32 v109, 1, v108
    v_lshl_add_u32 v97, v109, 3, v97
    buffer_load_ushort v108, v97, s[16:19], s56 offen
    buffer_load_ushort v109, v97, s[16:19], s57 offen
    v_add_u32 v99, -1, v99
ob_j_43:
    v_lshrrev_b32 v110, 1, v99
    v_lshl_add_u32 v97, v110, 8, v98
    v_and_b32 v110, 1, v99
    v_lshl_add_u32 v97, v110, 3, v97
    buffer_load_dwordx2 v[104:105], v97, s[16:19], s56 offen
    buffer_load_dwordx2 v[106:107], v97, s[16:19], s57 offen
    s_waitcnt vmcnt(0)
    v_lshlrev_b32 v176, 16, v112
    v_and_b32 v177, 0xffff0000, v112
    v_lshlrev_b32 v178, 16, v113
    v_and_b32 v179, 0xffff0000, v113
    v_lshlrev_b32 v180, 16, v114
    v_and_b32 v181, 0xffff0000, v114
    v_lshlrev_b32 v182, 16, v115
    v_and_b32 v183, 0xffff0000, v115
    v_lshlrev_b32 v200, 16, v116
    v_and_b32 v201, 0xffff0000, v116
    v_add_f32 v176, v176, v200
    v_add_f32 v177, v177, v201
    v_lshlrev_b32 v200, 16, v117
    v_and_b32 v201, 0xffff0000, v117
    v_add_f32 v178, v178, v200
    v_add_f32 v179, v179, v201
    v_lshlrev_b32 v200, 16, v118
    v_and_b32 v201, 0xffff0000, v118
    v_add_f32 v180, v180, v200
    v_add_f32 v181, v181, v201
    v_lshlrev_b32 v200, 16, v119
    v_and_b32 v201, 0xffff0000, v119
    v_add_f32 v182, v182, v200
    v_add_f32 v183, v183, v201
    v_lshlrev_b32 v200, 16, v120
    v_and_b32 v201, 0xffff0000, v120
    v_add_f32 v176, v176, v200
    v_add_f32 v177, v177, v201
    v_lshlrev_b32 v200, 16, v121
    v_and_b32 v201, 0xffff0000, v121
    v_add_f32 v178, v178, v200
    v_add_f32 v179, v179, v201
    v_lshlrev_b32 v200, 16, v122
    v_and_b32 v201, 0xffff0000, v122
    v_add_f32 v180, v180, v200
    v_add_f32 v181, v181, v201
    v_lshlrev_b32 v200, 16, v123
    v_and_b32 v201, 0xffff0000, v123
    v_add_f32 v182, v182, v200
    v_add_f32 v183, v183, v201
    v_lshlrev_b32 v200, 16, v124
    v_and_b32 v201, 0xffff0000, v124
    v_add_f32 v176, v176, v200
    v_add_f32 v177, v177, v201
    v_lshlrev_b32 v200, 16, v125
    v_and_b32 v201, 0xffff0000, v125
    v_add_f32 v178, v178, v200
    v_add_f32 v179, v179, v201
    v_lshlrev_b32 v200, 16, v126
    v_and_b32 v201, 0xffff0000, v126
    v_add_f32 v180, v180, v200
    v_add_f32 v181, v181, v201
    v_lshlrev_b32 v200, 16, v127
    v_and_b32 v201, 0xffff0000, v127
    v_add_f32 v182, v182, v200
    v_add_f32 v183, v183, v201
    v_lshlrev_b32 v200, 16, v128
    v_and_b32 v201, 0xffff0000, v128
    v_add_f32 v176, v176, v200
    v_add_f32 v177, v177, v201
    v_lshlrev_b32 v200, 16, v129
    v_and_b32 v201, 0xffff0000, v129
    v_add_f32 v178, v178, v200
    v_add_f32 v179, v179, v201
    v_lshlrev_b32 v200, 16, v130
    v_and_b32 v201, 0xffff0000, v130
    v_add_f32 v180, v180, v200
    v_add_f32 v181, v181, v201
    v_lshlrev_b32 v200, 16, v131
    v_and_b32 v201, 0xffff0000, v131
    v_add_f32 v182, v182, v200
    v_add_f32 v183, v183, v201
    v_lshlrev_b32 v200, 16, v132
    v_and_b32 v201, 0xffff0000, v132
    v_add_f32 v176, v176, v200
    v_add_f32 v177, v177, v201
    v_lshlrev_b32 v200, 16, v133
    v_and_b32 v201, 0xffff0000, v133
    v_add_f32 v178, v178, v200
    v_add_f32 v179, v179, v201
    v_lshlrev_b32 v200, 16, v134
    v_and_b32 v201, 0xffff0000, v134
    v_add_f32 v180, v180, v200
    v_add_f32 v181, v181, v201
    v_lshlrev_b32 v200, 16, v135
    v_and_b32 v201, 0xffff0000, v135
    v_add_f32 v182, v182, v200
    v_add_f32 v183, v183, v201
    v_lshlrev_b32 v200, 16, v136
    v_and_b32 v201, 0xffff0000, v136
    v_add_f32 v176, v176, v200
    v_add_f32 v177, v177, v201
    v_lshlrev_b32 v200, 16, v137
    v_and_b32 v201, 0xffff0000, v137
    v_add_f32 v178, v178, v200
    v_add_f32 v179, v179, v201
    v_lshlrev_b32 v200, 16, v138
    v_and_b32 v201, 0xffff0000, v138
    v_add_f32 v180, v180, v200
    v_add_f32 v181, v181, v201
    v_lshlrev_b32 v200, 16, v139
    v_and_b32 v201, 0xffff0000, v139
    v_add_f32 v182, v182, v200
    v_add_f32 v183, v183, v201
    v_lshlrev_b32 v200, 16, v140
    v_and_b32 v201, 0xffff0000, v140
    v_add_f32 v176, v176, v200
    v_add_f32 v177, v177, v201
    v_lshlrev_b32 v200, 16, v141
    v_and_b32 v201, 0xffff0000, v141
    v_add_f32 v178, v178, v200
    v_add_f32 v179, v179, v201
    v_lshlrev_b32 v200, 16, v142
    v_and_b32 v201, 0xffff0000, v142
    v_add_f32 v180, v180, v200
    v_add_f32 v181, v181, v201
    v_lshlrev_b32 v200, 16, v143
    v_and_b32 v201, 0xffff0000, v143
    v_add_f32 v182, v182, v200
    v_add_f32 v183, v183, v201
    s_cmp_ge_u32 s68, 18
    s_cbranch_scc1 op_m_44
    v_lshlrev_b32 v200, 16, v104
    v_and_b32 v201, 0xffff0000, v104
    v_lshlrev_b32 v202, 16, v105
    v_and_b32 v203, 0xffff0000, v105
    v_lshlrev_b32 v204, 16, v106
    v_and_b32 v205, 0xffff0000, v106
    v_lshlrev_b32 v206, 16, v107
    v_and_b32 v207, 0xffff0000, v107
    s_branch op_j_45
op_m_44:
    v_lshlrev_b32 v200, 16, v108
    v_and_b32 v201, 0xffff0000, v105
    v_lshlrev_b32 v202, 16, v105
    v_and_b32 v203, 0xffff0000, v104
    v_lshlrev_b32 v204, 16, v109
    v_and_b32 v205, 0xffff0000, v107
    v_lshlrev_b32 v206, 16, v107
    v_and_b32 v207, 0xffff0000, v106
op_j_45:
    v_fmac_f32 v200, v176, v100
    v_fmac_f32 v201, v177, v101
    v_fmac_f32 v202, v178, v102
    v_fmac_f32 v203, v179, v103
    v_fmac_f32 v204, v180, v100
    v_fmac_f32 v205, v181, v101
    v_fmac_f32 v206, v182, v102
    v_fmac_f32 v207, v183, v103
    v_cvt_pk_bf16_f32 v176, v200, v201
    v_cvt_pk_bf16_f32 v177, v202, v203
    v_cvt_pk_bf16_f32 v178, v204, v205
    v_cvt_pk_bf16_f32 v179, v206, v207
    s_movk_i32 s54, 18432
    buffer_store_dwordx2 v[176:177], v96, s[64:67], 0 offen sc1
    buffer_store_dwordx2 v[178:179], v96, s[64:67], s54 offen sc1
k4_n8_39:
    s_barrier
    s_endpgm
k4_help_33:
    s_setprio 2
    s_mul_i32 s38, s28, 1152
    s_mul_i32 s39, s28, 663552
    s_sub_u32 s30, s30, 4
    s_mul_i32 s32, s30, 18432
    s_mov_b32 s44, s32
    s_add_u32 s49, s32, 147456
    s_mul_i32 s37, s30, 165888
    s_add_u32 s39, s39, s37
    s_mul_i32 s37, s30, 36864
    s_add_u32 s45, s38, s37
    s_sub_u32 s35, s38, s37
    s_sub_u32 s40, 5207040, s37
    s_cmp_eq_u32 s30, 0
    s_cselect_b32 s41, 2552832, s40
    s_movk_i32 s37, 911
    v_add_u32 v2, 0, v3
    v_mul_u32_u24 v4, s37, v2
    v_lshrrev_b32 v4, 16, v4
    v_mul_u32_u24 v23, 72, v4
    v_sub_u32 v2, v2, v23
    v_and_b32 v23, 6, v4
    v_xor_b32 v2, v2, v23
    v_lshlrev_b32 v2, 4, v2
    v_and_b32 v14, 4, v4
    v_add_u32 v14, v14, v4
    v_sub_u32 v23, 11, v14
    v_mul_u32_u24 v14, 9216, v14
    v_mul_u32_u24 v23, 9216, v23
    v_add_u32 v14, v14, v2
    v_add_u32 v23, v23, v2
    v_add_u32 v2, 64, v3
    v_mul_u32_u24 v4, s37, v2
    v_lshrrev_b32 v4, 16, v4
    v_mul_u32_u24 v24, 72, v4
    v_sub_u32 v2, v2, v24
    v_and_b32 v24, 6, v4
    v_xor_b32 v2, v2, v24
    v_lshlrev_b32 v2, 4, v2
    v_and_b32 v15, 4, v4
    v_add_u32 v15, v15, v4
    v_sub_u32 v24, 11, v15
    v_mul_u32_u24 v15, 9216, v15
    v_mul_u32_u24 v24, 9216, v24
    v_add_u32 v15, v15, v2
    v_add_u32 v24, v24, v2
    v_add_u32 v2, 128, v3
    v_mul_u32_u24 v4, s37, v2
    v_lshrrev_b32 v4, 16, v4
    v_mul_u32_u24 v25, 72, v4
    v_sub_u32 v2, v2, v25
    v_and_b32 v25, 6, v4
    v_xor_b32 v2, v2, v25
    v_lshlrev_b32 v2, 4, v2
    v_and_b32 v16, 4, v4
    v_add_u32 v16, v16, v4
    v_sub_u32 v25, 11, v16
    v_mul_u32_u24 v16, 9216, v16
    v_mul_u32_u24 v25, 9216, v25
    v_add_u32 v16, v16, v2
    v_add_u32 v25, v25, v2
    v_add_u32 v2, 192, v3
    v_mul_u32_u24 v4, s37, v2
    v_lshrrev_b32 v4, 16, v4
    v_mul_u32_u24 v26, 72, v4
    v_sub_u32 v2, v2, v26
    v_and_b32 v26, 6, v4
    v_xor_b32 v2, v2, v26
    v_lshlrev_b32 v2, 4, v2
    v_and_b32 v17, 4, v4
    v_add_u32 v17, v17, v4
    v_sub_u32 v26, 11, v17
    v_mul_u32_u24 v17, 9216, v17
    v_mul_u32_u24 v26, 9216, v26
    v_add_u32 v17, v17, v2
    v_add_u32 v26, v26, v2
    v_add_u32 v2, 256, v3
    v_mul_u32_u24 v4, s37, v2
    v_lshrrev_b32 v4, 16, v4
    v_mul_u32_u24 v27, 72, v4
    v_sub_u32 v2, v2, v27
    v_and_b32 v27, 6, v4
    v_xor_b32 v2, v2, v27
    v_lshlrev_b32 v2, 4, v2
    v_and_b32 v18, 4, v4
    v_add_u32 v18, v18, v4
    v_sub_u32 v27, 11, v18
    v_mul_u32_u24 v18, 9216, v18
    v_mul_u32_u24 v27, 9216, v27
    v_add_u32 v18, v18, v2
    v_add_u32 v27, v27, v2
    v_add_u32 v2, 320, v3
    v_mul_u32_u24 v4, s37, v2
    v_lshrrev_b32 v4, 16, v4
    v_mul_u32_u24 v28, 72, v4
    v_sub_u32 v2, v2, v28
    v_and_b32 v28, 6, v4
    v_xor_b32 v2, v2, v28
    v_lshlrev_b32 v2, 4, v2
    v_and_b32 v19, 4, v4
    v_add_u32 v19, v19, v4
    v_sub_u32 v28, 11, v19
    v_mul_u32_u24 v19, 9216, v19
    v_mul_u32_u24 v28, 9216, v28
    v_add_u32 v19, v19, v2
    v_add_u32 v28, v28, v2
    v_add_u32 v2, 384, v3
    v_mul_u32_u24 v4, s37, v2
    v_lshrrev_b32 v4, 16, v4
    v_mul_u32_u24 v29, 72, v4
    v_sub_u32 v2, v2, v29
    v_and_b32 v29, 6, v4
    v_xor_b32 v2, v2, v29
    v_lshlrev_b32 v2, 4, v2
    v_and_b32 v20, 4, v4
    v_add_u32 v20, v20, v4
    v_sub_u32 v29, 11, v20
    v_mul_u32_u24 v20, 9216, v20
    v_mul_u32_u24 v29, 9216, v29
    v_add_u32 v20, v20, v2
    v_add_u32 v29, v29, v2
    v_add_u32 v2, 448, v3
    v_mul_u32_u24 v4, s37, v2
    v_lshrrev_b32 v4, 16, v4
    v_mul_u32_u24 v30, 72, v4
    v_sub_u32 v2, v2, v30
    v_and_b32 v30, 6, v4
    v_xor_b32 v2, v2, v30
    v_lshlrev_b32 v2, 4, v2
    v_and_b32 v21, 4, v4
    v_add_u32 v21, v21, v4
    v_sub_u32 v30, 11, v21
    v_mul_u32_u24 v21, 9216, v21
    v_mul_u32_u24 v30, 9216, v30
    v_add_u32 v21, v21, v2
    v_add_u32 v30, v30, v2
    v_add_u32 v2, 512, v3
    v_mul_u32_u24 v4, s37, v2
    v_lshrrev_b32 v4, 16, v4
    v_mul_u32_u24 v31, 72, v4
    v_sub_u32 v2, v2, v31
    v_and_b32 v31, 6, v4
    v_xor_b32 v2, v2, v31
    v_lshlrev_b32 v2, 4, v2
    v_and_b32 v22, 4, v4
    v_add_u32 v22, v22, v4
    v_sub_u32 v31, 11, v22
    v_mul_u32_u24 v22, 9216, v22
    v_mul_u32_u24 v31, 9216, v31
    v_add_u32 v22, v22, v2
    v_add_u32 v31, v31, v2
    v_lshrrev_b32 v2, 3, v3
    v_and_b32 v4, 6, v2
    v_and_b32 v32, 7, v3
    v_xor_b32 v32, v32, v4
    v_lshlrev_b32 v32, 4, v32
    v_mul_u32_u24 v2, 1152, v2
    v_add_u32 v32, v32, v2
    s_waitcnt lgkmcnt(0)
    s_mov_b32 s46, 0
    s_branch k4_dds_48
    .p2align 6
k4_dd_47:
    s_waitcnt vmcnt(36)
    s_barrier
k4_dds_48:
    s_add_u32 m0, s44, 0
    s_nop 0
    buffer_load_dwordx4 v14, s[20:23], s45 offen lds
    s_add_u32 m0, s44, 1024
    s_nop 0
    buffer_load_dwordx4 v15, s[20:23], s45 offen lds
    s_add_u32 m0, s44, 2048
    s_nop 0
    buffer_load_dwordx4 v16, s[20:23], s45 offen lds
    s_add_u32 m0, s44, 3072
    s_nop 0
    buffer_load_dwordx4 v17, s[20:23], s45 offen lds
    s_add_u32 m0, s44, 4096
    s_nop 0
    buffer_load_dwordx4 v18, s[20:23], s45 offen lds
    s_add_u32 m0, s44, 5120
    s_nop 0
    buffer_load_dwordx4 v19, s[20:23], s45 offen lds
    s_add_u32 m0, s44, 6144
    s_nop 0
    buffer_load_dwordx4 v20, s[20:23], s45 offen lds
    s_add_u32 m0, s44, 7168
    s_nop 0
    buffer_load_dwordx4 v21, s[20:23], s45 offen lds
    s_add_u32 m0, s44, 8192
    s_nop 0
    buffer_load_dwordx4 v22, s[20:23], s45 offen lds
    s_add_u32 m0, s44, 9216
    s_add_u32 s45, s45, 147456
    buffer_load_dwordx4 v14, s[20:23], s45 offen lds
    s_add_u32 m0, s44, 10240
    s_nop 0
    buffer_load_dwordx4 v15, s[20:23], s45 offen lds
    s_add_u32 m0, s44, 11264
    s_nop 0
    buffer_load_dwordx4 v16, s[20:23], s45 offen lds
    s_add_u32 m0, s44, 12288
    s_add_u32 s51, s44, 36864
    s_cmp_ge_u32 s51, s49
    s_cselect_b32 s51, s32, s51
    buffer_load_dwordx4 v17, s[20:23], s45 offen lds
    s_add_u32 m0, s44, 13312
    s_add_u32 s46, s46, 1
    buffer_load_dwordx4 v18, s[20:23], s45 offen lds
    s_add_u32 m0, s44, 14336
    s_nop 0
    buffer_load_dwordx4 v19, s[20:23], s45 offen lds
    s_add_u32 m0, s44, 15360
    s_nop 0
    buffer_load_dwordx4 v20, s[20:23], s45 offen lds
    s_add_u32 m0, s44, 16384
    s_nop 0
    buffer_load_dwordx4 v21, s[20:23], s45 offen lds
    s_add_u32 m0, s44, 17408
    s_mov_b32 s44, s51
    s_mov_b32 s50, s45
    s_add_u32 s45, s45, 147456
    s_sub_u32 s52, s46, 3
    s_cmp_lt_u32 s52, 6
    buffer_load_dwordx4 v22, s[20:23], s50 offen lds
    s_cbranch_scc1 k4_dd_47
    s_cmp_lt_u32 s46, 3
    s_cbranch_scc1 k4_dds_48
    v_cmp_le_u32 vcc, 101376, v23
    v_add_u32 v14, s40, v23
    v_add_u32 v4, s41, v23
    v_cndmask_b32 v14, v14, v4, vcc
    v_cmp_le_u32 vcc, 101376, v24
    v_add_u32 v15, s40, v24
    v_add_u32 v4, s41, v24
    v_cndmask_b32 v15, v15, v4, vcc
    v_cmp_le_u32 vcc, 101376, v25
    v_add_u32 v16, s40, v25
    v_add_u32 v4, s41, v25
    v_cndmask_b32 v16, v16, v4, vcc
    v_cmp_le_u32 vcc, 101376, v26
    v_add_u32 v17, s40, v26
    v_add_u32 v4, s41, v26
    v_cndmask_b32 v17, v17, v4, vcc
    v_cmp_le_u32 vcc, 101376, v27
    v_add_u32 v18, s40, v27
    v_add_u32 v4, s41, v27
    v_cndmask_b32 v18, v18, v4, vcc
    v_cmp_le_u32 vcc, 101376, v28
    v_add_u32 v19, s40, v28
    v_add_u32 v4, s41, v28
    v_cndmask_b32 v19, v19, v4, vcc
    v_cmp_le_u32 vcc, 101376, v29
    v_add_u32 v20, s40, v29
    v_add_u32 v4, s41, v29
    v_cndmask_b32 v20, v20, v4, vcc
    v_cmp_le_u32 vcc, 101376, v30
    v_add_u32 v21, s40, v30
    v_add_u32 v4, s41, v30
    v_cndmask_b32 v21, v21, v4, vcc
    v_cmp_le_u32 vcc, 101376, v31
    v_add_u32 v22, s40, v31
    v_add_u32 v4, s41, v31
    v_cndmask_b32 v22, v22, v4, vcc
    s_mov_b32 s45, s38
    s_waitcnt vmcnt(36)
    s_barrier
    s_add_u32 m0, s44, 0
    s_nop 0
    buffer_load_dwordx4 v14, s[20:23], s45 offen lds
    s_add_u32 m0, s44, 1024
    s_nop 0
    buffer_load_dwordx4 v15, s[20:23], s45 offen lds
    s_add_u32 m0, s44, 2048
    s_nop 0
    buffer_load_dwordx4 v16, s[20:23], s45 offen lds
    s_add_u32 m0, s44, 3072
    s_nop 0
    buffer_load_dwordx4 v17, s[20:23], s45 offen lds
    s_add_u32 m0, s44, 4096
    s_nop 0
    buffer_load_dwordx4 v18, s[20:23], s45 offen lds
    s_add_u32 m0, s44, 5120
    s_nop 0
    buffer_load_dwordx4 v19, s[20:23], s45 offen lds
    s_add_u32 m0, s44, 6144
    s_nop 0
    buffer_load_dwordx4 v20, s[20:23], s45 offen lds
    s_add_u32 m0, s44, 7168
    s_nop 0
    buffer_load_dwordx4 v21, s[20:23], s45 offen lds
    s_add_u32 m0, s44, 8192
    s_nop 0
    buffer_load_dwordx4 v22, s[20:23], s45 offen lds
    s_add_u32 s45, s35, 5207040
    s_branch k4_dms_50
    .p2align 6
k4_dm_49:
    s_waitcnt vmcnt(36)
    s_barrier
    s_add_u32 m0, s44, 0
    s_nop 0
    buffer_load_dwordx4 v23, s[20:23], s45 offen lds
    s_add_u32 m0, s44, 1024
    s_nop 0
    buffer_load_dwordx4 v24, s[20:23], s45 offen lds
    s_add_u32 m0, s44, 2048
    s_nop 0
    buffer_load_dwordx4 v25, s[20:23], s45 offen lds
    s_add_u32 m0, s44, 3072
    s_nop 0
    buffer_load_dwordx4 v26, s[20:23], s45 offen lds
    s_add_u32 m0, s44, 4096
    s_nop 0
    buffer_load_dwordx4 v27, s[20:23], s45 offen lds
    s_add_u32 m0, s44, 5120
    s_nop 0
    buffer_load_dwordx4 v28, s[20:23], s45 offen lds
    s_add_u32 m0, s44, 6144
    s_nop 0
    buffer_load_dwordx4 v29, s[20:23], s45 offen lds
    s_add_u32 m0, s44, 7168
    s_nop 0
    buffer_load_dwordx4 v30, s[20:23], s45 offen lds
    s_add_u32 m0, s44, 8192
    s_nop 0
    buffer_load_dwordx4 v31, s[20:23], s45 offen lds
k4_dms_50:
    s_add_u32 m0, s44, 9216
    s_add_u32 s45, s45, -147456
    buffer_load_dwordx4 v23, s[20:23], s45 offen lds
    s_add_u32 m0, s44, 10240
    s_nop 0
    buffer_load_dwordx4 v24, s[20:23], s45 offen lds
    s_add_u32 m0, s44, 11264
    s_nop 0
    buffer_load_dwordx4 v25, s[20:23], s45 offen lds
    s_add_u32 m0, s44, 12288
    s_add_u32 s51, s44, 36864
    s_cmp_ge_u32 s51, s49
    s_cselect_b32 s51, s32, s51
    buffer_load_dwordx4 v26, s[20:23], s45 offen lds
    s_add_u32 m0, s44, 13312
    s_add_u32 s46, s46, 1
    buffer_load_dwordx4 v27, s[20:23], s45 offen lds
    s_add_u32 m0, s44, 14336
    s_nop 0
    buffer_load_dwordx4 v28, s[20:23], s45 offen lds
    s_add_u32 m0, s44, 15360
    s_nop 0
    buffer_load_dwordx4 v29, s[20:23], s45 offen lds
    s_add_u32 m0, s44, 16384
    s_nop 0
    buffer_load_dwordx4 v30, s[20:23], s45 offen lds
    s_add_u32 m0, s44, 17408
    s_mov_b32 s44, s51
    s_mov_b32 s50, s45
    s_add_u32 s45, s45, -147456
    s_cmp_lt_u32 s46, 18
    buffer_load_dwordx4 v31, s[20:23], s50 offen lds
    s_cbranch_scc1 k4_dm_49
    s_add_u32 s45, s39, 1024
    .p2align 6
k4_dw_51:
    s_waitcnt vmcnt(36)
    s_barrier
k4_dws_52:
    s_add_u32 m0, s44, 0
    s_mov_b32 s50, s45
    buffer_load_dwordx4 v32, s[24:27], s50 offen lds
    s_add_u32 m0, s44, 1024
    s_add_u32 s50, s50, 9216
    buffer_load_dwordx4 v32, s[24:27], s50 offen lds
    s_add_u32 m0, s44, 2048
    s_add_u32 s50, s50, 9216
    buffer_load_dwordx4 v32, s[24:27], s50 offen lds
    s_add_u32 m0, s44, 3072
    s_add_u32 s50, s50, 9216
    buffer_load_dwordx4 v32, s[24:27], s50 offen lds
    s_add_u32 m0, s44, 4096
    s_add_u32 s50, s50, 9216
    buffer_load_dwordx4 v32, s[24:27], s50 offen lds
    s_add_u32 m0, s44, 5120
    s_add_u32 s50, s50, 9216
    buffer_load_dwordx4 v32, s[24:27], s50 offen lds
    s_add_u32 m0, s44, 6144
    s_add_u32 s50, s50, 9216
    buffer_load_dwordx4 v32, s[24:27], s50 offen lds
    s_add_u32 m0, s44, 7168
    s_add_u32 s50, s50, 9216
    buffer_load_dwordx4 v32, s[24:27], s50 offen lds
    s_add_u32 m0, s44, 8192
    s_add_u32 s50, s50, 9216
    buffer_load_dwordx4 v32, s[24:27], s50 offen lds
    s_add_u32 m0, s44, 9216
    s_add_u32 s50, s50, 9216
    buffer_load_dwordx4 v32, s[24:27], s50 offen lds
    s_add_u32 m0, s44, 10240
    s_add_u32 s50, s50, 9216
    s_sub_u32 s53, s46, 17
    s_lshr_b32 s54, s53, 1
    s_add_u32 s55, s54, s28
    s_and_b32 s55, s55, 7
    s_cmp_eq_u32 s54, 0
    s_cselect_b32 s55, 8, s55
    s_lshl_b32 s55, s55, 7
    s_and_b32 s53, s53, 1
    s_mul_i32 s53, s53, 331776
    s_add_u32 s55, s55, s53
    s_add_u32 s45, s39, s55
    buffer_load_dwordx4 v32, s[24:27], s50 offen lds
    s_add_u32 m0, s44, 11264
    s_add_u32 s50, s50, 9216
    buffer_load_dwordx4 v32, s[24:27], s50 offen lds
    s_add_u32 m0, s44, 12288
    s_add_u32 s50, s50, 9216
    s_add_u32 s51, s44, 36864
    s_cmp_ge_u32 s51, s49
    s_cselect_b32 s51, s32, s51
    buffer_load_dwordx4 v32, s[24:27], s50 offen lds
    s_add_u32 m0, s44, 13312
    s_add_u32 s50, s50, 9216
    s_add_u32 s46, s46, 1
    buffer_load_dwordx4 v32, s[24:27], s50 offen lds
    s_add_u32 m0, s44, 14336
    s_add_u32 s50, s50, 9216
    buffer_load_dwordx4 v32, s[24:27], s50 offen lds
    s_add_u32 m0, s44, 15360
    s_add_u32 s50, s50, 9216
    buffer_load_dwordx4 v32, s[24:27], s50 offen lds
    s_add_u32 m0, s44, 16384
    s_add_u32 s50, s50, 9216
    buffer_load_dwordx4 v32, s[24:27], s50 offen lds
    s_add_u32 m0, s44, 17408
    s_add_u32 s50, s50, 9216
    s_mov_b32 s44, s51
    s_sub_u32 s52, s46, 23
    s_cmp_lt_u32 s52, 13
    buffer_load_dwordx4 v32, s[24:27], s50 offen lds
    s_cbranch_scc1 k4_dw_51
    s_cmp_eq_u32 s46, 19
    s_cbranch_scc1 k4_dw_51
    s_cmp_eq_u32 s46, 20
    s_cbranch_scc1 k4_x20_53
    s_cmp_eq_u32 s46, 21
    s_cbranch_scc1 k4_x21_54
    s_cmp_eq_u32 s46, 22
    s_cbranch_scc1 k4_dws_52
    s_branch k4_dfin_55
k4_x20_53:
    s_waitcnt vmcnt(36)
    s_barrier
    s_waitcnt vmcnt(18)
    s_barrier
    s_barrier
    s_barrier
    s_branch k4_dws_52
k4_x21_54:
    s_waitcnt vmcnt(18)
    s_barrier
    s_branch k4_dws_52
k4_dfin_55:
    s_waitcnt vmcnt(36)
    s_barrier
    s_waitcnt vmcnt(18)
    s_barrier
    s_waitcnt vmcnt(0)
    s_barrier
    s_mov_b32 s62, s30
k4_red_46:
    v_lshlrev_b32 v2, 2, v3
    v_cmp_gt_u32 vcc, 8, v3
    v_mov_b32 v4, 0x40000000
    s_mul_i32 s63, s29, 1152
    s_add_u32 s63, s63, 327680
    v_cndmask_b32 v2, v4, v2, vcc
    s_mov_b32 s69, 0
    s_lshl_b32 s59, s28, 7
    s_add_u32 s59, s59, s63
    s_and_b32 s60, s69, 62
    s_cmp_eq_u32 s60, 62
    s_cbranch_scc1 k4_polld_57
    s_mov_b32 s61, 0
k4_poll_56:
    v_mov_b32 v4, 0
    buffer_atomic_add v4, v2, s[16:19], s59 offen sc0
    s_waitcnt vmcnt(0)
    v_cmp_eq_u32 vcc, 4, v4
    s_add_u32 s61, s61, 1
    s_mov_b32 s69, vcc_lo
    s_and_b32 s60, s69, 62
    s_cmp_eq_u32 s60, 62
    s_cbranch_scc1 k4_polld_57
    s_cmp_lt_u32 s61, 0x40000
    s_cbranch_scc1 k4_poll_56
k4_polld_57:
    s_lshl_b32 s52, s28, 2
    s_and_b32 s53, s62, 2
    s_add_u32 s52, s52, s53
    s_add_u32 s58, s52, 1
    s_and_b32 s53, s62, 1
    s_mul_i32 s68, s29, 73728
    s_lshl_b32 s60, s52, 11
    s_add_u32 s68, s68, s60
    s_lshl_b32 s60, s53, 10
    s_add_u32 s68, s68, s60
    s_add_u32 s68, s68, 18874368
    s_sub_u32 s60, s28, 1
    s_and_b32 s60, s60, 7
    s_mul_i32 s60, s60, 2359296
    s_add_u32 s60, s60, s68
    buffer_load_dwordx4 v[112:115], v1, s[16:19], s60 offen offset:0 sc1
    buffer_load_dwordx4 v[116:119], v1, s[16:19], s60 offen offset:2048 sc1
    s_sub_u32 s60, s28, 2
    s_and_b32 s60, s60, 7
    s_mul_i32 s60, s60, 2359296
    s_add_u32 s60, s60, s68
    buffer_load_dwordx4 v[120:123], v1, s[16:19], s60 offen offset:0 sc1
    buffer_load_dwordx4 v[124:127], v1, s[16:19], s60 offen offset:2048 sc1
    s_sub_u32 s60, s28, 3
    s_and_b32 s60, s60, 7
    s_mul_i32 s60, s60, 2359296
    s_add_u32 s60, s60, s68
    buffer_load_dwordx4 v[128:131], v1, s[16:19], s60 offen offset:0 sc1
    buffer_load_dwordx4 v[132:135], v1, s[16:19], s60 offen offset:2048 sc1
    s_sub_u32 s60, s28, 4
    s_and_b32 s60, s60, 7
    s_mul_i32 s60, s60, 2359296
    s_add_u32 s60, s60, s68
    buffer_load_dwordx4 v[136:139], v1, s[16:19], s60 offen offset:0 sc1
    buffer_load_dwordx4 v[140:143], v1, s[16:19], s60 offen offset:2048 sc1
    s_sub_u32 s60, s28, 5
    s_and_b32 s60, s60, 7
    s_mul_i32 s60, s60, 2359296
    s_add_u32 s60, s60, s68
    buffer_load_dwordx4 v[144:147], v1, s[16:19], s60 offen offset:0 sc1
    buffer_load_dwordx4 v[148:151], v1, s[16:19], s60 offen offset:2048 sc1
    v_lshrrev_b32 v67, 4, v3
    s_lshl_b32 s54, s52, 2
    v_add_u32 v67, s54, v67
    s_lshl_b32 s55, s29, 1
    s_add_u32 s55, s55, s53
    s_mul_i32 s56, s55, 36864
    s_add_u32 s56, s56, 3145728
    s_add_u32 s57, s56, 18432
    v_lshlrev_b32 v65, 4, v67
    s_mov_b32 s54, 11520
    buffer_load_dwordx4 v[68:71], v65, s[16:19], s54 offen
    s_lshl_b32 s55, s55, 5
    v_and_b32 v66, 15, v3
    v_add_u32 v64, s55, v66
    v_mul_u32_u24 v64, 1152, v64
    v_lshl_add_u32 v64, v67, 3, v64
    v_lshlrev_b32 v66, 4, v66
    s_cmp_lt_u32 s52, 18
    s_cbranch_scc1 ob_j_59
    v_sub_u32 v67, 216, v67
    v_cmp_eq_u32 vcc, 144, v67
    v_mov_b32 v76, 72
    s_nop 0
    v_cndmask_b32 v76, v67, v76, vcc
    v_lshrrev_b32 v77, 1, v76
    v_lshl_add_u32 v65, v77, 8, v66
    v_and_b32 v77, 1, v76
    v_lshl_add_u32 v65, v77, 3, v65
    buffer_load_ushort v76, v65, s[16:19], s56 offen
    buffer_load_ushort v77, v65, s[16:19], s57 offen
    v_add_u32 v67, -1, v67
ob_j_59:
    v_lshrrev_b32 v78, 1, v67
    v_lshl_add_u32 v65, v78, 8, v66
    v_and_b32 v78, 1, v67
    v_lshl_add_u32 v65, v78, 3, v65
    buffer_load_dwordx2 v[72:73], v65, s[16:19], s56 offen
    buffer_load_dwordx2 v[74:75], v65, s[16:19], s57 offen
    v_lshrrev_b32 v83, 4, v3
    s_lshl_b32 s54, s58, 2
    v_add_u32 v83, s54, v83
    s_lshl_b32 s55, s29, 1
    s_add_u32 s55, s55, s53
    s_mul_i32 s56, s55, 36864
    s_add_u32 s56, s56, 3145728
    s_add_u32 s57, s56, 18432
    v_lshlrev_b32 v81, 4, v83
    s_mov_b32 s54, 11520
    buffer_load_dwordx4 v[84:87], v81, s[16:19], s54 offen
    s_lshl_b32 s55, s55, 5
    v_and_b32 v82, 15, v3
    v_add_u32 v80, s55, v82
    v_mul_u32_u24 v80, 1152, v80
    v_lshl_add_u32 v80, v83, 3, v80
    v_lshlrev_b32 v82, 4, v82
    s_cmp_lt_u32 s58, 18
    s_cbranch_scc1 ob_j_61
    v_sub_u32 v83, 216, v83
    v_cmp_eq_u32 vcc, 144, v83
    v_mov_b32 v92, 72
    s_nop 0
    v_cndmask_b32 v92, v83, v92, vcc
    v_lshrrev_b32 v93, 1, v92
    v_lshl_add_u32 v81, v93, 8, v82
    v_and_b32 v93, 1, v92
    v_lshl_add_u32 v81, v93, 3, v81
    buffer_load_ushort v92, v81, s[16:19], s56 offen
    buffer_load_ushort v93, v81, s[16:19], s57 offen
    v_add_u32 v83, -1, v83
ob_j_61:
    v_lshrrev_b32 v94, 1, v83
    v_lshl_add_u32 v81, v94, 8, v82
    v_and_b32 v94, 1, v83
    v_lshl_add_u32 v81, v94, 3, v81
    buffer_load_dwordx2 v[88:89], v81, s[16:19], s56 offen
    buffer_load_dwordx2 v[90:91], v81, s[16:19], s57 offen
    v_lshrrev_b32 v200, 4, v3
    v_lshlrev_b32 v201, 3, v200
    v_sub_u32 v79, v64, v201
    v_and_b32 v201, 1, v200
    v_lshl_add_u32 v79, v201, 5, v79
    v_lshrrev_b32 v201, 1, v200
    v_lshl_add_u32 v79, v201, 4, v79
    s_and_b32 s60, s69, 192
    s_cmp_eq_u32 s60, 192
    s_cbranch_scc1 k4_polld_63
    s_mov_b32 s61, 0
k4_poll_62:
    v_mov_b32 v4, 0
    buffer_atomic_add v4, v2, s[16:19], s59 offen sc0
    s_waitcnt vmcnt(0)
    v_cmp_eq_u32 vcc, 4, v4
    s_add_u32 s61, s61, 1
    s_mov_b32 s69, vcc_lo
    s_and_b32 s60, s69, 192
    s_cmp_eq_u32 s60, 192
    s_cbranch_scc1 k4_polld_63
    s_cmp_lt_u32 s61, 0x40000
    s_cbranch_scc1 k4_poll_62
k4_polld_63:
    s_sub_u32 s60, s28, 6
    s_and_b32 s60, s60, 7
    s_mul_i32 s60, s60, 2359296
    s_add_u32 s60, s60, s68
    buffer_load_dwordx4 v[152:155], v1, s[16:19], s60 offen offset:0 sc1
    buffer_load_dwordx4 v[156:159], v1, s[16:19], s60 offen offset:2048 sc1
    s_sub_u32 s60, s28, 7
    s_and_b32 s60, s60, 7
    s_mul_i32 s60, s60, 2359296
    s_add_u32 s60, s60, s68
    buffer_load_dwordx4 v[160:163], v1, s[16:19], s60 offen offset:0 sc1
    buffer_load_dwordx4 v[164:167], v1, s[16:19], s60 offen offset:2048 sc1
    s_waitcnt vmcnt(4)
    v_lshlrev_b32 v176, 16, v112
    v_and_b32 v177, 0xffff0000, v112
    v_lshlrev_b32 v178, 16, v113
    v_and_b32 v179, 0xffff0000, v113
    v_lshlrev_b32 v180, 16, v114
    v_and_b32 v181, 0xffff0000, v114
    v_lshlrev_b32 v182, 16, v115
    v_and_b32 v183, 0xffff0000, v115
    v_lshlrev_b32 v184, 16, v116
    v_and_b32 v185, 0xffff0000, v116
    v_lshlrev_b32 v186, 16, v117
    v_and_b32 v187, 0xffff0000, v117
    v_lshlrev_b32 v188, 16, v118
    v_and_b32 v189, 0xffff0000, v118
    v_lshlrev_b32 v190, 16, v119
    v_and_b32 v191, 0xffff0000, v119
    s_waitcnt vmcnt(4)
    v_lshlrev_b32 v200, 16, v120
    v_and_b32 v201, 0xffff0000, v120
    v_add_f32 v176, v176, v200
    v_add_f32 v177, v177, v201
    v_lshlrev_b32 v200, 16, v121
    v_and_b32 v201, 0xffff0000, v121
    v_add_f32 v178, v178, v200
    v_add_f32 v179, v179, v201
    v_lshlrev_b32 v200, 16, v122
    v_and_b32 v201, 0xffff0000, v122
    v_add_f32 v180, v180, v200
    v_add_f32 v181, v181, v201
    v_lshlrev_b32 v200, 16, v123
    v_and_b32 v201, 0xffff0000, v123
    v_add_f32 v182, v182, v200
    v_add_f32 v183, v183, v201
    v_lshlrev_b32 v200, 16, v124
    v_and_b32 v201, 0xffff0000, v124
    v_add_f32 v184, v184, v200
    v_add_f32 v185, v185, v201
    v_lshlrev_b32 v200, 16, v125
    v_and_b32 v201, 0xffff0000, v125
    v_add_f32 v186, v186, v200
    v_add_f32 v187, v187, v201
    v_lshlrev_b32 v200, 16, v126
    v_and_b32 v201, 0xffff0000, v126
    v_add_f32 v188, v188, v200
    v_add_f32 v189, v189, v201
    v_lshlrev_b32 v200, 16, v127
    v_and_b32 v201, 0xffff0000, v127
    v_add_f32 v190, v190, v200
    v_add_f32 v191, v191, v201
    s_waitcnt vmcnt(4)
    v_lshlrev_b32 v200, 16, v128
    v_and_b32 v201, 0xffff0000, v128
    v_add_f32 v176, v176, v200
    v_add_f32 v177, v177, v201
    v_lshlrev_b32 v200, 16, v129
    v_and_b32 v201, 0xffff0000, v129
    v_add_f32 v178, v178, v200
    v_add_f32 v179, v179, v201
    v_lshlrev_b32 v200, 16, v130
    v_and_b32 v201, 0xffff0000, v130
    v_add_f32 v180, v180, v200
    v_add_f32 v181, v181, v201
    v_lshlrev_b32 v200, 16, v131
    v_and_b32 v201, 0xffff0000, v131
    v_add_f32 v182, v182, v200
    v_add_f32 v183, v183, v201
    v_lshlrev_b32 v200, 16, v132
    v_and_b32 v201, 0xffff0000, v132
    v_add_f32 v184, v184, v200
    v_add_f32 v185, v185, v201
    v_lshlrev_b32 v200, 16, v133
    v_and_b32 v201, 0xffff0000, v133
    v_add_f32 v186, v186, v200
    v_add_f32 v187, v187, v201
    v_lshlrev_b32 v200, 16, v134
    v_and_b32 v201, 0xffff0000, v134
    v_add_f32 v188, v188, v200
    v_add_f32 v189, v189, v201
    v_lshlrev_b32 v200, 16, v135
    v_and_b32 v201, 0xffff0000, v135
    v_add_f32 v190, v190, v200
    v_add_f32 v191, v191, v201
    s_waitcnt vmcnt(4)
    v_lshlrev_b32 v200, 16, v136
    v_and_b32 v201, 0xffff0000, v136
    v_add_f32 v176, v176, v200
    v_add_f32 v177, v177, v201
    v_lshlrev_b32 v200, 16, v137
    v_and_b32 v201, 0xffff0000, v137
    v_add_f32 v178, v178, v200
    v_add_f32 v179, v179, v201
    v_lshlrev_b32 v200, 16, v138
    v_and_b32 v201, 0xffff0000, v138
    v_add_f32 v180, v180, v200
    v_add_f32 v181, v181, v201
    v_lshlrev_b32 v200, 16, v139
    v_and_b32 v201, 0xffff0000, v139
    v_add_f32 v182, v182, v200
    v_add_f32 v183, v183, v201
    v_lshlrev_b32 v200, 16, v140
    v_and_b32 v201, 0xffff0000, v140
    v_add_f32 v184, v184, v200
    v_add_f32 v185, v185, v201
    v_lshlrev_b32 v200, 16, v141
    v_and_b32 v201, 0xffff0000, v141
    v_add_f32 v186, v186, v200
    v_add_f32 v187, v187, v201
    v_lshlrev_b32 v200, 16, v142
    v_and_b32 v201, 0xffff0000, v142
    v_add_f32 v188, v188, v200
    v_add_f32 v189, v189, v201
    v_lshlrev_b32 v200, 16, v143
    v_and_b32 v201, 0xffff0000, v143
    v_add_f32 v190, v190, v200
    v_add_f32 v191, v191, v201
    s_waitcnt vmcnt(4)
    v_lshlrev_b32 v200, 16, v144
    v_and_b32 v201, 0xffff0000, v144
    v_add_f32 v176, v176, v200
    v_add_f32 v177, v177, v201
    v_lshlrev_b32 v200, 16, v145
    v_and_b32 v201, 0xffff0000, v145
    v_add_f32 v178, v178, v200
    v_add_f32 v179, v179, v201
    v_lshlrev_b32 v200, 16, v146
    v_and_b32 v201, 0xffff0000, v146
    v_add_f32 v180, v180, v200
    v_add_f32 v181, v181, v201
    v_lshlrev_b32 v200, 16, v147
    v_and_b32 v201, 0xffff0000, v147
    v_add_f32 v182, v182, v200
    v_add_f32 v183, v183, v201
    v_lshlrev_b32 v200, 16, v148
    v_and_b32 v201, 0xffff0000, v148
    v_add_f32 v184, v184, v200
    v_add_f32 v185, v185, v201
    v_lshlrev_b32 v200, 16, v149
    v_and_b32 v201, 0xffff0000, v149
    v_add_f32 v186, v186, v200
    v_add_f32 v187, v187, v201
    v_lshlrev_b32 v200, 16, v150
    v_and_b32 v201, 0xffff0000, v150
    v_add_f32 v188, v188, v200
    v_add_f32 v189, v189, v201
    v_lshlrev_b32 v200, 16, v151
    v_and_b32 v201, 0xffff0000, v151
    v_add_f32 v190, v190, v200
    v_add_f32 v191, v191, v201
    s_waitcnt vmcnt(2)
    v_lshlrev_b32 v200, 16, v152
    v_and_b32 v201, 0xffff0000, v152
    v_add_f32 v176, v176, v200
    v_add_f32 v177, v177, v201
    v_lshlrev_b32 v200, 16, v153
    v_and_b32 v201, 0xffff0000, v153
    v_add_f32 v178, v178, v200
    v_add_f32 v179, v179, v201
    v_lshlrev_b32 v200, 16, v154
    v_and_b32 v201, 0xffff0000, v154
    v_add_f32 v180, v180, v200
    v_add_f32 v181, v181, v201
    v_lshlrev_b32 v200, 16, v155
    v_and_b32 v201, 0xffff0000, v155
    v_add_f32 v182, v182, v200
    v_add_f32 v183, v183, v201
    v_lshlrev_b32 v200, 16, v156
    v_and_b32 v201, 0xffff0000, v156
    v_add_f32 v184, v184, v200
    v_add_f32 v185, v185, v201
    v_lshlrev_b32 v200, 16, v157
    v_and_b32 v201, 0xffff0000, v157
    v_add_f32 v186, v186, v200
    v_add_f32 v187, v187, v201
    v_lshlrev_b32 v200, 16, v158
    v_and_b32 v201, 0xffff0000, v158
    v_add_f32 v188, v188, v200
    v_add_f32 v189, v189, v201
    v_lshlrev_b32 v200, 16, v159
    v_and_b32 v201, 0xffff0000, v159
    v_add_f32 v190, v190, v200
    v_add_f32 v191, v191, v201
    s_waitcnt vmcnt(0)
    v_lshlrev_b32 v200, 16, v160
    v_and_b32 v201, 0xffff0000, v160
    v_add_f32 v176, v176, v200
    v_add_f32 v177, v177, v201
    v_lshlrev_b32 v200, 16, v161
    v_and_b32 v201, 0xffff0000, v161
    v_add_f32 v178, v178, v200
    v_add_f32 v179, v179, v201
    v_lshlrev_b32 v200, 16, v162
    v_and_b32 v201, 0xffff0000, v162
    v_add_f32 v180, v180, v200
    v_add_f32 v181, v181, v201
    v_lshlrev_b32 v200, 16, v163
    v_and_b32 v201, 0xffff0000, v163
    v_add_f32 v182, v182, v200
    v_add_f32 v183, v183, v201
    v_lshlrev_b32 v200, 16, v164
    v_and_b32 v201, 0xffff0000, v164
    v_add_f32 v184, v184, v200
    v_add_f32 v185, v185, v201
    v_lshlrev_b32 v200, 16, v165
    v_and_b32 v201, 0xffff0000, v165
    v_add_f32 v186, v186, v200
    v_add_f32 v187, v187, v201
    v_lshlrev_b32 v200, 16, v166
    v_and_b32 v201, 0xffff0000, v166
    v_add_f32 v188, v188, v200
    v_add_f32 v189, v189, v201
    v_lshlrev_b32 v200, 16, v167
    v_and_b32 v201, 0xffff0000, v167
    v_add_f32 v190, v190, v200
    v_add_f32 v191, v191, v201
    s_lshl_b32 s60, s62, 12
    v_add_u32 v2, s60, v1
    s_barrier
    ds_read_b128 v[208:211], v2 offset:0
    ds_read_b128 v[212:215], v2 offset:1024
    ds_read_b128 v[216:219], v2 offset:2048
    ds_read_b128 v[220:223], v2 offset:3072
    s_waitcnt lgkmcnt(0)
    v_add_f32 v176, v176, v208
    v_add_f32 v177, v177, v209
    v_add_f32 v178, v178, v210
    v_add_f32 v179, v179, v211
    v_add_f32 v180, v180, v212
    v_add_f32 v181, v181, v213
    v_add_f32 v182, v182, v214
    v_add_f32 v183, v183, v215
    v_add_f32 v184, v184, v216
    v_add_f32 v185, v185, v217
    v_add_f32 v186, v186, v218
    v_add_f32 v187, v187, v219
    v_add_f32 v188, v188, v220
    v_add_f32 v189, v189, v221
    v_add_f32 v190, v190, v222
    v_add_f32 v191, v191, v223
    s_cmp_ge_u32 s52, 18
    s_cbranch_scc1 op_m_64
    v_lshlrev_b32 v200, 16, v72
    v_and_b32 v201, 0xffff0000, v72
    v_lshlrev_b32 v202, 16, v73
    v_and_b32 v203, 0xffff0000, v73
    v_lshlrev_b32 v204, 16, v74
    v_and_b32 v205, 0xffff0000, v74
    v_lshlrev_b32 v206, 16, v75
    v_and_b32 v207, 0xffff0000, v75
    s_branch op_j_65
op_m_64:
    v_lshlrev_b32 v200, 16, v76
    v_and_b32 v201, 0xffff0000, v73
    v_lshlrev_b32 v202, 16, v73
    v_and_b32 v203, 0xffff0000, v72
    v_lshlrev_b32 v204, 16, v77
    v_and_b32 v205, 0xffff0000, v75
    v_lshlrev_b32 v206, 16, v75
    v_and_b32 v207, 0xffff0000, v74
op_j_65:
    v_fmac_f32 v200, v176, v68
    v_fmac_f32 v201, v177, v69
    v_fmac_f32 v202, v178, v70
    v_fmac_f32 v203, v179, v71
    v_fmac_f32 v204, v180, v68
    v_fmac_f32 v205, v181, v69
    v_fmac_f32 v206, v182, v70
    v_fmac_f32 v207, v183, v71
    v_cvt_pk_bf16_f32 v208, v200, v201
    v_cvt_pk_bf16_f32 v209, v202, v203
    v_cvt_pk_bf16_f32 v212, v204, v205
    v_cvt_pk_bf16_f32 v213, v206, v207
    s_cmp_ge_u32 s58, 18
    s_cbranch_scc1 op_m_66
    v_lshlrev_b32 v112, 16, v88
    v_and_b32 v113, 0xffff0000, v88
    v_lshlrev_b32 v114, 16, v89
    v_and_b32 v115, 0xffff0000, v89
    v_lshlrev_b32 v116, 16, v90
    v_and_b32 v117, 0xffff0000, v90
    v_lshlrev_b32 v118, 16, v91
    v_and_b32 v119, 0xffff0000, v91
    s_branch op_j_67
op_m_66:
    v_lshlrev_b32 v112, 16, v92
    v_and_b32 v113, 0xffff0000, v89
    v_lshlrev_b32 v114, 16, v89
    v_and_b32 v115, 0xffff0000, v88
    v_lshlrev_b32 v116, 16, v93
    v_and_b32 v117, 0xffff0000, v91
    v_lshlrev_b32 v118, 16, v91
    v_and_b32 v119, 0xffff0000, v90
op_j_67:
    v_fmac_f32 v112, v184, v84
    v_fmac_f32 v113, v185, v85
    v_fmac_f32 v114, v186, v86
    v_fmac_f32 v115, v187, v87
    v_fmac_f32 v116, v188, v84
    v_fmac_f32 v117, v189, v85
    v_fmac_f32 v118, v190, v86
    v_fmac_f32 v119, v191, v87
    v_cvt_pk_bf16_f32 v210, v112, v113
    v_cvt_pk_bf16_f32 v211, v114, v115
    v_cvt_pk_bf16_f32 v214, v116, v117
    v_cvt_pk_bf16_f32 v215, v118, v119
    s_nop 1
    v_permlane16_swap_b32 v208, v210
    v_permlane16_swap_b32 v209, v211
    v_permlane16_swap_b32 v212, v214
    v_permlane16_swap_b32 v213, v215
    s_movk_i32 s54, 18432
    buffer_store_dwordx4 v[208:211], v79, s[64:67], 0 offen sc1
    buffer_store_dwordx4 v[212:215], v79, s[64:67], s54 offen sc1
    s_endpgm
k4_norm_34:
    s_setprio 2
    s_sub_u32 s30, s30, 6
    s_lshl_b32 s34, s29, 1
    s_add_u32 s34, s34, s30
    s_mul_i32 s35, s34, 36864
    s_add_u32 s35, s35, 3145728
    s_add_u32 s31, s35, 18432
    v_and_b32 v2, 15, v0
    s_lshl_b32 s36, s34, 5
    v_add_u32 v2, s36, v2
    v_lshlrev_b32 v2, 3, v2
    s_mov_b32 s36, 131072
    s_mov_b32 m0, 155648
    s_mov_b32 s37, 6912
    s_waitcnt lgkmcnt(0)
    buffer_load_dwordx2 v[36:37], v2, s[16:19], s36 offen offset:0
    buffer_load_dwordx2 v[48:49], v2, s[16:19], s36 offen offset:128
    s_add_u32 s36, s36, 16384
    buffer_load_dwordx2 v[38:39], v2, s[16:19], s36 offen offset:0
    buffer_load_dwordx2 v[50:51], v2, s[16:19], s36 offen offset:128
    s_add_u32 s36, s36, 16384
    buffer_load_dwordx2 v[40:41], v2, s[16:19], s36 offen offset:0
    buffer_load_dwordx2 v[52:53], v2, s[16:19], s36 offen offset:128
    s_add_u32 s36, s36, 16384
    buffer_load_dwordx2 v[42:43], v2, s[16:19], s36 offen offset:0
    buffer_load_dwordx2 v[54:55], v2, s[16:19], s36 offen offset:128
    s_add_u32 s36, s36, 16384
    buffer_load_dwordx2 v[44:45], v2, s[16:19], s36 offen offset:0
    buffer_load_dwordx2 v[56:57], v2, s[16:19], s36 offen offset:128
    s_add_u32 s36, s36, 16384
    buffer_load_dwordx2 v[46:47], v2, s[16:19], s36 offen offset:0
    buffer_load_dwordx2 v[58:59], v2, s[16:19], s36 offen offset:128
    s_add_u32 s36, s36, 16384
    buffer_load_dwordx4 v1, s[16:19], s37 offen offset:0 lds
    buffer_load_dwordx4 v1, s[16:19], s37 offen offset:1024 lds
    buffer_load_dwordx4 v1, s[16:19], s37 offen offset:2048 lds
    buffer_load_dwordx4 v1, s[16:19], s37 offen offset:3072 lds
    s_mov_b32 m0, 159744
    s_mov_b32 s37, 11008
    buffer_load_dwordx4 v1, s[16:19], s37 offen lds
    buffer_load_dwordx4 v[76:79], v1, s[16:19], s35 offen offset:0
    buffer_load_dwordx4 v[80:83], v1, s[16:19], s31 offen offset:0
    buffer_load_dwordx4 v[84:87], v1, s[16:19], s35 offen offset:1024
    buffer_load_dwordx4 v[88:91], v1, s[16:19], s31 offen offset:1024
    buffer_load_dwordx4 v[92:95], v1, s[16:19], s35 offen offset:2048
    buffer_load_dwordx4 v[96:99], v1, s[16:19], s31 offen offset:2048
    buffer_load_dwordx4 v[100:103], v1, s[16:19], s35 offen offset:3072
    buffer_load_dwordx4 v[104:107], v1, s[16:19], s31 offen offset:3072
    s_add_u32 s35, s35, 4096
    s_add_u32 s31, s31, 4096
    buffer_load_dwordx4 v[108:111], v1, s[16:19], s35 offen offset:0
    buffer_load_dwordx4 v[112:115], v1, s[16:19], s31 offen offset:0
    buffer_load_dwordx4 v[116:119], v1, s[16:19], s35 offen offset:1024
    buffer_load_dwordx4 v[120:123], v1, s[16:19], s31 offen offset:1024
    s_lshl_b32 s37, s30, 11
    s_add_u32 s37, s37, 147456
    v_add_u32 v9, s37, v1
    v_lshrrev_b32 v10, 4, v3
    v_lshlrev_b32 v10, 5, v10
    v_add_u32 v10, 155648, v10
    s_mov_b32 s36, 0x3ae38e39
    s_mov_b32 s37, 0x3727c5ac
    s_waitcnt vmcnt(12)
    ds_read_b128 v[20:23], v10 offset:0
    ds_read_b128 v[24:27], v10 offset:16
    ds_read_b128 v[28:31], v10 offset:2304
    ds_read_b128 v[32:35], v10 offset:2320
    v_add_u32 v10, 128, v10
    v_pk_add_f32 v[36:37], v[36:37], v[38:39]
    v_pk_add_f32 v[36:37], v[36:37], v[40:41]
    v_pk_add_f32 v[36:37], v[36:37], v[42:43]
    v_pk_add_f32 v[36:37], v[36:37], v[44:45]
    v_pk_add_f32 v[36:37], v[36:37], v[46:47]
    v_mul_f32 v36, s36, v36
    v_mul_f32 v37, s36, v37
    v_fma_f32 v37, -v36, v36, v37
    v_max_f32 v37, 0, v37
    v_cvt_pk_bf16_f32 v37, v37, v37
    v_and_b32 v37, 0xffff0000, v37
    v_add_f32 v37, s37, v37
    v_cvt_pk_bf16_f32 v37, v37, v37
    v_and_b32 v37, 0xffff0000, v37
    v_sqrt_f32 v37, v37
    s_nop 0
    v_cvt_pk_bf16_f32 v37, v37, v37
    v_and_b32 v37, 0xffff0000, v37
    v_rcp_f32 v11, v37
    v_cvt_pk_bf16_f32 v36, v36, v36
    v_and_b32 v36, 0xffff0000, v36
    v_mul_f32 v13, -v36, v11
    v_pk_add_f32 v[48:49], v[48:49], v[50:51]
    v_pk_add_f32 v[48:49], v[48:49], v[52:53]
    v_pk_add_f32 v[48:49], v[48:49], v[54:55]
    v_pk_add_f32 v[48:49], v[48:49], v[56:57]
    v_pk_add_f32 v[48:49], v[48:49], v[58:59]
    v_mul_f32 v48, s36, v48
    v_mul_f32 v49, s36, v49
    v_fma_f32 v49, -v48, v48, v49
    v_max_f32 v49, 0, v49
    v_cvt_pk_bf16_f32 v49, v49, v49
    v_and_b32 v49, 0xffff0000, v49
    v_add_f32 v49, s37, v49
    v_cvt_pk_bf16_f32 v49, v49, v49
    v_and_b32 v49, 0xffff0000, v49
    v_sqrt_f32 v49, v49
    s_nop 0
    v_cvt_pk_bf16_f32 v49, v49, v49
    v_and_b32 v49, 0xffff0000, v49
    v_rcp_f32 v12, v49
    v_cvt_pk_bf16_f32 v48, v48, v48
    v_and_b32 v48, 0xffff0000, v48
    v_mul_f32 v14, -v48, v12
    s_mov_b32 s44, 0
    s_mov_b32 s45, 0
    s_mov_b32 s46, 2
    s_waitcnt vmcnt(8)
    s_set_gpr_idx_on s45, gpr_idx(SRC1)
    s_add_u32 s44, s44, 1
    v_lshlrev_b32 v36, 16, v76
    v_and_b32 v37, 0xffff0000, v76
    v_lshlrev_b32 v38, 16, v77
    v_and_b32 v39, 0xffff0000, v77
    v_lshlrev_b32 v40, 16, v78
    v_and_b32 v41, 0xffff0000, v78
    v_lshlrev_b32 v42, 16, v79
    v_and_b32 v43, 0xffff0000, v79
    v_lshlrev_b32 v44, 16, v80
    v_and_b32 v45, 0xffff0000, v80
    v_lshlrev_b32 v46, 16, v81
    v_and_b32 v47, 0xffff0000, v81
    v_lshlrev_b32 v48, 16, v82
    v_and_b32 v49, 0xffff0000, v82
    v_lshlrev_b32 v50, 16, v83
    v_and_b32 v51, 0xffff0000, v83
    s_set_gpr_idx_off
    s_add_u32 s45, s45, 8
    v_fma_f32 v36, v36, v11, v13
    v_fma_f32 v37, v37, v11, v13
    v_fma_f32 v38, v38, v11, v13
    v_fma_f32 v39, v39, v11, v13
    v_fma_f32 v40, v40, v11, v13
    v_fma_f32 v41, v41, v11, v13
    v_fma_f32 v42, v42, v11, v13
    v_fma_f32 v43, v43, v11, v13
    v_fma_f32 v44, v44, v12, v14
    v_fma_f32 v45, v45, v12, v14
    v_fma_f32 v46, v46, v12, v14
    v_fma_f32 v47, v47, v12, v14
    v_fma_f32 v48, v48, v12, v14
    v_fma_f32 v49, v49, v12, v14
    v_fma_f32 v50, v50, v12, v14
    v_fma_f32 v51, v51, v12, v14
    s_waitcnt lgkmcnt(0)
    v_fma_f32 v36, v36, v28, v20
    v_fma_f32 v37, v37, v29, v21
    v_fma_f32 v38, v38, v30, v22
    v_fma_f32 v39, v39, v31, v23
    v_fma_f32 v40, v40, v32, v24
    v_fma_f32 v41, v41, v33, v25
    v_fma_f32 v42, v42, v34, v26
    v_fma_f32 v43, v43, v35, v27
    v_fma_f32 v44, v44, v28, v20
    v_fma_f32 v45, v45, v29, v21
    v_fma_f32 v46, v46, v30, v22
    v_fma_f32 v47, v47, v31, v23
    v_fma_f32 v48, v48, v32, v24
    v_fma_f32 v49, v49, v33, v25
    v_fma_f32 v50, v50, v34, v26
    v_fma_f32 v51, v51, v35, v27
    ds_read_b128 v[20:23], v10 offset:0
    ds_read_b128 v[24:27], v10 offset:16
    ds_read_b128 v[28:31], v10 offset:2304
    ds_read_b128 v[32:35], v10 offset:2320
    v_add_u32 v10, 128, v10
    v_cvt_pk_bf16_f32 v60, v36, v37
    v_cvt_pk_bf16_f32 v61, v38, v39
    v_cvt_pk_bf16_f32 v62, v40, v41
    v_cvt_pk_bf16_f32 v63, v42, v43
    v_cvt_pk_bf16_f32 v64, v44, v45
    v_cvt_pk_bf16_f32 v65, v46, v47
    v_cvt_pk_bf16_f32 v66, v48, v49
    v_cvt_pk_bf16_f32 v67, v50, v51
    s_branch k4_nin_69
    .p2align 6
k4_nl_68:
    s_barrier
k4_nin_69:
    s_set_gpr_idx_on s45, gpr_idx(SRC1)
    s_add_u32 s44, s44, 1
    v_lshlrev_b32 v36, 16, v76
    v_and_b32 v37, 0xffff0000, v76
    v_lshlrev_b32 v38, 16, v77
    v_and_b32 v39, 0xffff0000, v77
    v_lshlrev_b32 v40, 16, v78
    v_and_b32 v41, 0xffff0000, v78
    v_lshlrev_b32 v42, 16, v79
    v_and_b32 v43, 0xffff0000, v79
    v_lshlrev_b32 v44, 16, v80
    v_and_b32 v45, 0xffff0000, v80
    v_lshlrev_b32 v46, 16, v81
    v_and_b32 v47, 0xffff0000, v81
    v_lshlrev_b32 v48, 16, v82
    v_and_b32 v49, 0xffff0000, v82
    v_lshlrev_b32 v50, 16, v83
    v_and_b32 v51, 0xffff0000, v83
    s_set_gpr_idx_off
    s_add_u32 s45, s45, 8
    v_fma_f32 v36, v36, v11, v13
    v_fma_f32 v37, v37, v11, v13
    v_fma_f32 v38, v38, v11, v13
    v_fma_f32 v39, v39, v11, v13
    v_fma_f32 v40, v40, v11, v13
    v_fma_f32 v41, v41, v11, v13
    v_fma_f32 v42, v42, v11, v13
    v_fma_f32 v43, v43, v11, v13
    v_fma_f32 v44, v44, v12, v14
    v_fma_f32 v45, v45, v12, v14
    v_fma_f32 v46, v46, v12, v14
    v_fma_f32 v47, v47, v12, v14
    v_fma_f32 v48, v48, v12, v14
    v_fma_f32 v49, v49, v12, v14
    v_fma_f32 v50, v50, v12, v14
    v_fma_f32 v51, v51, v12, v14
    ds_write_b128 v9, v[60:63] offset:0
    ds_write_b128 v9, v[64:67] offset:1024
    v_xor_b32 v9, 4096, v9
    s_waitcnt lgkmcnt(2)
    v_fma_f32 v36, v36, v28, v20
    v_fma_f32 v37, v37, v29, v21
    v_fma_f32 v38, v38, v30, v22
    v_fma_f32 v39, v39, v31, v23
    v_fma_f32 v40, v40, v32, v24
    v_fma_f32 v41, v41, v33, v25
    v_fma_f32 v42, v42, v34, v26
    v_fma_f32 v43, v43, v35, v27
    v_fma_f32 v44, v44, v28, v20
    v_fma_f32 v45, v45, v29, v21
    v_fma_f32 v46, v46, v30, v22
    v_fma_f32 v47, v47, v31, v23
    v_fma_f32 v48, v48, v32, v24
    v_fma_f32 v49, v49, v33, v25
    v_fma_f32 v50, v50, v34, v26
    v_fma_f32 v51, v51, v35, v27
    s_waitcnt lgkmcnt(0)
    ds_read_b128 v[20:23], v10 offset:0
    ds_read_b128 v[24:27], v10 offset:16
    ds_read_b128 v[28:31], v10 offset:2304
    ds_read_b128 v[32:35], v10 offset:2320
    v_add_u32 v10, 128, v10
    v_cvt_pk_bf16_f32 v60, v36, v37
    v_cvt_pk_bf16_f32 v61, v38, v39
    v_cvt_pk_bf16_f32 v62, v40, v41
    v_cvt_pk_bf16_f32 v63, v42, v43
    v_cvt_pk_bf16_f32 v64, v44, v45
    v_cvt_pk_bf16_f32 v65, v46, v47
    v_cvt_pk_bf16_f32 v66, v48, v49
    v_cvt_pk_bf16_f32 v67, v50, v51
    s_cmp_lg_u32 s44, s46
    s_cbranch_scc1 k4_nl_68
    s_barrier
k4_ev_71:
    s_cmp_lg_u32 s44, 2
    s_cbranch_scc1 k4_ev_72
    s_waitcnt vmcnt(0)
    buffer_load_dwordx4 v[124:127], v1, s[16:19], s35 offen offset:2048
    buffer_load_dwordx4 v[128:131], v1, s[16:19], s31 offen offset:2048
    buffer_load_dwordx4 v[132:135], v1, s[16:19], s35 offen offset:3072
    buffer_load_dwordx4 v[136:139], v1, s[16:19], s31 offen offset:3072
    s_add_u32 s35, s35, 4096
    s_add_u32 s31, s31, 4096
    buffer_load_dwordx4 v[140:143], v1, s[16:19], s35 offen offset:0
    buffer_load_dwordx4 v[144:147], v1, s[16:19], s31 offen offset:0
    buffer_load_dwordx4 v[148:151], v1, s[16:19], s35 offen offset:1024
    buffer_load_dwordx4 v[152:155], v1, s[16:19], s31 offen offset:1024
    buffer_load_dwordx4 v[156:159], v1, s[16:19], s35 offen offset:2048
    buffer_load_dwordx4 v[160:163], v1, s[16:19], s31 offen offset:2048
    buffer_load_dwordx4 v[164:167], v1, s[16:19], s35 offen offset:3072
    buffer_load_dwordx4 v[168:171], v1, s[16:19], s31 offen offset:3072
    s_add_u32 s35, s35, 4096
    s_add_u32 s31, s31, 4096
    s_mov_b32 s46, 4
    s_branch k4_nin_69
k4_ev_72:
    s_cmp_lg_u32 s44, 4
    s_cbranch_scc1 k4_ev_73
    buffer_load_dwordx4 v[172:175], v1, s[16:19], s35 offen offset:0
    buffer_load_dwordx4 v[176:179], v1, s[16:19], s31 offen offset:0
    buffer_load_dwordx4 v[180:183], v1, s[16:19], s35 offen offset:1024
    buffer_load_dwordx4 v[184:187], v1, s[16:19], s31 offen offset:1024
    buffer_load_dwordx4 v[188:191], v1, s[16:19], s35 offen offset:2048
    buffer_load_dwordx4 v[192:195], v1, s[16:19], s31 offen offset:2048
    buffer_load_dwordx4 v[196:199], v1, s[16:19], s35 offen offset:3072
    buffer_load_dwordx4 v[200:203], v1, s[16:19], s31 offen offset:3072
    s_add_u32 s35, s35, 4096
    s_add_u32 s31, s31, 4096
    buffer_load_dwordx4 v[204:207], v1, s[16:19], s35 offen offset:0
    buffer_load_dwordx4 v[208:211], v1, s[16:19], s31 offen offset:0
    buffer_load_dwordx4 v[212:215], v1, s[16:19], s35 offen offset:1024
    buffer_load_dwordx4 v[216:219], v1, s[16:19], s31 offen offset:1024
    s_mov_b32 s46, 6
    s_branch k4_nin_69
k4_ev_73:
    s_cmp_lg_u32 s44, 6
    s_cbranch_scc1 k4_ev_74
    s_waitcnt vmcnt(12)
    s_mov_b32 s46, 12
    s_branch k4_nin_69
k4_ev_74:
    s_cmp_lg_u32 s44, 12
    s_cbranch_scc1 k4_ev_75
    s_waitcnt vmcnt(0)
    s_mov_b32 s46, 18
    s_branch k4_nin_69
k4_ev_75:
    ds_write_b128 v9, v[60:63] offset:0
    ds_write_b128 v9, v[64:67] offset:1024
    v_xor_b32 v9, 4096, v9
    s_waitcnt lgkmcnt(0)
    s_barrier
    s_mov_b32 s52, 0
k4_sl_76:
    s_barrier
    s_add_u32 s52, s52, 1
    s_cmp_lt_u32 s52, 20
    s_cbranch_scc1 k4_sl_76
    s_add_u32 s62, s30, 2
    s_branch k4_red_46
code_end:
k4_end_32:
    s_endpgm
.section .rodata,"a"
.p2align 6
.amdhsa_kernel k1_mod_kernel
  .amdhsa_next_free_vgpr 128
  .amdhsa_next_free_sgpr 76
  .amdhsa_accum_offset 128
  .amdhsa_group_segment_fixed_size 0
  .amdhsa_kernarg_size 104
  .amdhsa_user_sgpr_count 2
  .amdhsa_user_sgpr_kernarg_segment_ptr 1
  .amdhsa_system_sgpr_workgroup_id_x 1
  .amdhsa_float_denorm_mode_32 3
.end_amdhsa_kernel
.p2align 6
.amdhsa_kernel k2_hid_kernel
  .amdhsa_next_free_vgpr 256
  .amdhsa_next_free_sgpr 80
  .amdhsa_accum_offset 256
  .amdhsa_group_segment_fixed_size 0
  .amdhsa_kernarg_size 104
  .amdhsa_user_sgpr_count 2
  .amdhsa_user_sgpr_kernarg_segment_ptr 1
  .amdhsa_system_sgpr_workgroup_id_x 1
  .amdhsa_float_denorm_mode_32 3
.end_amdhsa_kernel
.p2align 6
.amdhsa_kernel k3_seq_kernel
  .amdhsa_next_free_vgpr 232
  .amdhsa_next_free_sgpr 72
  .amdhsa_accum_offset 232
  .amdhsa_group_segment_fixed_size 0
  .amdhsa_kernarg_size 104
  .amdhsa_user_sgpr_count 2
  .amdhsa_user_sgpr_kernarg_segment_ptr 1
  .amdhsa_system_sgpr_workgroup_id_x 1
  .amdhsa_float_denorm_mode_32 3
.end_amdhsa_kernel
.p2align 6
.amdhsa_kernel k4_mlp_kernel
  .amdhsa_next_free_vgpr 236
  .amdhsa_next_free_sgpr 76
  .amdhsa_accum_offset 236
  .amdhsa_group_segment_fixed_size 0
  .amdhsa_kernarg_size 104
  .amdhsa_user_sgpr_count 2
  .amdhsa_user_sgpr_kernarg_segment_ptr 1
  .amdhsa_system_sgpr_workgroup_id_x 1
  .amdhsa_float_denorm_mode_32 3
.end_amdhsa_kernel
```
